```python
import torch

def _softmax(x, axis=-1):
    return torch.softmax(x, dim=axis)
def _gelu(x):
    return torch.nn.functional.gelu(x, approximate="tanh")
def _silu(x):
    return torch.nn.functional.silu(x)
def _sigmoid(x):
    return torch.sigmoid(x)
def _layernorm(x, axis=-1, eps=1e-5):
    m = x.mean(dim=axis, keepdim=True)
    v = x.var(dim=axis, keepdim=True, unbiased=False)
    return (x - m) / torch.sqrt(v + eps)
def _scatter_add(tgt, idx, src, axis=0):
    return tgt.clone().index_add_(axis, idx, src)
def _segment_sum(src, seg, n):
    out = torch.zeros((n,) + src.shape[1:], dtype=src.dtype)
    return out.index_add_(0, seg, src)
def _pad(x, pw):
    flat = tuple(v for pair in reversed(pw) for v in pair)
    return torch.nn.functional.pad(x, flat)

kernel_name = 'recurrent_scan__gqa_block_cached__glu_gated_reglu__decode'

def setup_inputs():

    _w = (lambda a: (lambda t: t.to(torch.bfloat16) if t.is_floating_point() else t)(torch.as_tensor(a)))
    def _A_setup():
        B, Sq, D = 4, 1, 640
        Hq, Hkv, Sk, Dh = 32, 32, 4096, 192
        assert Hq % Hkv == 0, (Hq, Hkv)
        return {
            "x": _w((lambda *s: torch.randn(*s, dtype=torch.bfloat16) * 0.05)(B, Sq, D)),
            "k_cache": _w((lambda *s: torch.randn(*s, dtype=torch.bfloat16) * 3.2)(B, Hkv, Sk, Dh)),
            "v_cache": _w((lambda *s: torch.randn(*s, dtype=torch.bfloat16) * 3.2)(B, Hkv, Sk, Dh)),
            "wq": _w((lambda *s: torch.randn(*s, dtype=torch.bfloat16) * 3.2)(D, Hq * Dh) * (D ** -0.5)),
            "wo": _w((lambda *s: torch.randn(*s, dtype=torch.bfloat16) * 3.2)(Hq * Dh, D) * ((Hq * Dh) ** -0.5)),
        }
    _A_in = _A_setup()

    def _B_setup():
        B, S, D, F = 4, 1, 640, 1536
        return {
            "x": _w((lambda *s: torch.randn(*s, dtype=torch.bfloat16) * 0.05)(B, S, D)),
            "W_gate": _w((lambda *s: torch.randn(*s, dtype=torch.bfloat16) * 0.4)(D, F) * (2.0 / D) ** 0.5),
            "W_up": _w((lambda *s: torch.randn(*s, dtype=torch.bfloat16) * 0.4)(D, F) * (2.0 / D) ** 0.5),
            "W_down": _w((lambda *s: torch.randn(*s, dtype=torch.bfloat16) * 0.4)(F, D) * (1.0 / F) ** 0.5),
        }
    _B_in = _B_setup()

    return {
        "A_x": _A_in["x"],
        "A_k_cache": _A_in["k_cache"],
        "A_v_cache": _A_in["v_cache"],
        "A_wq": _A_in["wq"],
        "A_wo": _A_in["wo"],
        "B_x": _B_in["x"],
        "B_W_gate": _B_in["W_gate"],
        "B_W_up": _B_in["W_up"],
        "B_W_down": _B_in["W_down"],
    }

def reference(A_x, A_k_cache, A_v_cache, A_wq, A_wo, B_x, B_W_gate, B_W_up, B_W_down):
    def _A_ref(x, k_cache, v_cache, wq, wo):
        B, Sq, D = x.shape
        Hq, Dh = 32, 192
        Hkv = k_cache.shape[1]
        rep = Hq // Hkv
        q = (lambda x, *d: x.permute(*d))((x @ wq).reshape(B, Sq, Hq, Dh), 0, 2, 1, 3)
        k = (lambda x, n, axis: torch.repeat_interleave(x, n, dim=axis))(k_cache, rep, axis=1)
        v = (lambda x, n, axis: torch.repeat_interleave(x, n, dim=axis))(v_cache, rep, axis=1)
        scores = torch.einsum("bhqd,bhkd->bhqk", q, k) * (Dh ** -0.5)
        p = _softmax(scores, axis=-1)
        o = torch.einsum("bhqk,bhkd->bhqd", p, v)
        return (lambda x, *d: x.permute(*d))(o, 0, 2, 1, 3).reshape(B, Sq, Hq * Dh) @ wo

    def _B_ref(x, W_gate, W_up, W_down):
        gate = torch.einsum("bsd,df->bsf", x, W_gate)
        up = torch.einsum("bsd,df->bsf", x, W_up)
        gate = gate * (lambda x, dt: x.to(dt))(gate > 0, gate.dtype)
        h = gate * up
        return torch.einsum("bsf,fd->bsd", h, W_down)

    x = A_x
    xn = _layernorm(x, axis=-1)
    s = _A_ref(xn, A_k_cache, A_v_cache, A_wq, A_wo)
    g = _silu(_B_ref(xn, B_W_gate, B_W_up, B_W_down))
    return x + s * g
```

```asm
; @launch grid=(256,1,1) block=(320,1,1) lds=147456
.amdgcn_target "amdgcn-amd-amdhsa--gfx950"
.text
.p2align 12
.globl recurrent_scan__gqa_block_cached__glu_gated_reglu__decode_kernel
.p2align 8
.type recurrent_scan__gqa_block_cached__glu_gated_reglu__decode_kernel,@function
recurrent_scan__gqa_block_cached__glu_gated_reglu__decode_kernel:
s_cmp_ge_u32 s2, 256
s_cbranch_scc1 L_end
s_load_dwordx16 s[4:19], s[0:1], 0
s_load_dwordx8 s[20:27], s[0:1], 64
v_lshrrev_b32 v12, 6, v0
v_and_b32 v1, 63, v0
v_readfirstlane_b32 s48, v12
v_lshlrev_b32 v2, 4, v1
s_lshr_b32 s65, s2, 3
s_lshl_b32 s65, s65, 2
s_and_b32 s66, s2, 3
s_add_u32 s3, s65, s66
s_bfe_u32 s52, s2, 0x10002
s_lshr_b32 s51, s3, 5
s_and_b32 s49, s3, 31
s_lshl_b32 s50, s51, 1
s_add_u32 s50, s50, s52
s_mul_i32 s69, s49, 3
s_add_u32 s69, s69, s50
s_mov_b32 s63, 0x3d93cd3a
s_mov_b32 s64, 0x3fb8aa3b
s_mov_b32 s46, 6291456
s_mov_b32 s47, 0x20000
s_cmp_eq_u32 s48, 4
s_cbranch_scc0 L_noprobe
s_mul_i32 s40, s2, 3
s_lshr_b32 s40, s40, 5
s_lshl_b32 s41, s40, 5
s_add_u32 s41, s41, 2
s_mul_i32 s41, s41, 43691
s_lshr_b32 s41, s41, 17
s_sub_u32 s41, s2, s41
s_cmp_ge_u32 s40, 12
s_cselect_b32 s65, 12, 0
s_sub_u32 s65, s40, s65
s_lshl_b32 s65, s65, 3
s_and_b32 s66, s41, 7
s_add_u32 s65, s65, s66
s_lshl_b32 s65, s65, 21
s_lshr_b32 s66, s41, 3
s_lshl_b32 s66, s66, 12
v_mov_b32 v16, 0
s_mov_b64 exec, 1
s_cmp_ge_u32 s40, 12
s_waitcnt lgkmcnt(0)
s_cselect_b32 s74, s8, s6
s_cselect_b32 s75, s9, s7
s_add_u32 s74, s74, s65
s_addc_u32 s75, s75, 0
s_bfe_u32 s65, s74, 0x10015
s_lshl_b32 s65, s65, 13
s_add_u32 s65, s65, s66
v_mov_b32 v12, s65
v_xor_b32 v13, 0x2000, v12
global_load_dword v14, v12, s[74:75] nt
global_load_dword v15, v13, s[74:75] nt
s_mov_b64 exec, -1
global_load_dword v3, v16, s[26:27] sc1
s_barrier
s_mov_b32 s44, s26
s_mov_b32 s45, s27
s_waitcnt vmcnt(2)
s_memtime s[36:37]
s_waitcnt vmcnt(1)
s_memtime s[38:39]
s_branch L_helper
L_noprobe:
s_cmp_ge_u32 s50, 3
s_cbranch_scc0 L_w1mlp
s_mov_b32 s53, s49
s_sub_u32 s54, s50, 3
s_mov_b32 s56, 12288
s_mov_b32 s55, 1
s_mul_i32 s70, s49, 384
s_branch L_w1done
L_w1mlp:
s_mul_i32 s66, s69, 52429
s_lshr_b32 s66, s66, 18
s_mul_i32 s67, s66, 5
s_sub_u32 s54, s69, s67
s_add_u32 s53, s66, 32
s_mov_b32 s56, 3072
s_cmp_lt_u32 s69, 80
s_cselect_b32 s55, 1, 0
s_and_b32 s66, s66, 7
s_mul_i32 s70, s66, 384
L_w1done:
s_lshl_b32 s66, s54, 2
s_add_u32 s66, s66, s48
s_lshl_b32 s66, s66, 5
s_mul_i32 s66, s66, s56
s_add_u32 s70, s70, s66
s_mul_i32 s66, s56, 31
s_add_u32 s66, s66, 384
s_mul_i32 s38, s66, s55
s_mov_b32 s39, 0x20000
v_add_u32 v12, 0, v1
v_mul_u32_u24 v13, 2731, v12
v_lshrrev_b32 v13, 16, v13
v_mul_u32_u24 v14, 24, v13
v_sub_u32 v12, v12, v14
v_lshlrev_b32 v12, 4, v12
v_and_b32 v15, 6, v13
v_lshlrev_b32 v15, 4, v15
v_xor_b32 v12, v12, v15
v_lshl_add_u32 v220, v14, 4, v12
v_mad_u32_u24 v28, v13, s56, v12
v_add_u32 v12, 64, v1
v_mul_u32_u24 v13, 2731, v12
v_lshrrev_b32 v13, 16, v13
v_mul_u32_u24 v14, 24, v13
v_sub_u32 v12, v12, v14
v_lshlrev_b32 v12, 4, v12
v_and_b32 v15, 6, v13
v_lshlrev_b32 v15, 4, v15
v_xor_b32 v12, v12, v15
v_lshl_add_u32 v221, v14, 4, v12
v_mad_u32_u24 v29, v13, s56, v12
v_add_u32 v12, 128, v1
v_mul_u32_u24 v13, 2731, v12
v_lshrrev_b32 v13, 16, v13
v_mul_u32_u24 v14, 24, v13
v_sub_u32 v12, v12, v14
v_lshlrev_b32 v12, 4, v12
v_and_b32 v15, 6, v13
v_lshlrev_b32 v15, 4, v15
v_xor_b32 v12, v12, v15
v_lshl_add_u32 v222, v14, 4, v12
v_mad_u32_u24 v30, v13, s56, v12
s_mul_i32 s57, s48, 18432
s_add_u32 s58, s57, 9216
s_mul_i32 s59, s48, 12288
s_add_u32 s59, s59, 73728
s_mul_i32 s65, s48, 1280
v_lshlrev_b32 v6, 2, v1
v_add_u32 v6, s65, v6
s_mul_i32 s72, s3, 1572864
s_cmp_lt_u32 s53, 40
s_waitcnt lgkmcnt(0)
s_cselect_b32 s36, s16, s18
s_cselect_b32 s37, s17, s19
s_cmp_lt_u32 s53, 32
s_cselect_b32 s36, s10, s36
s_cselect_b32 s37, s11, s37
s_add_u32 s36, s36, s70
s_addc_u32 s37, s37, 0
s_load_dword s97, s[36:37], 0
s_load_dword s98, s[4:5], 0
s_load_dword s99, s[26:27], 0
s_barrier
global_load_dword v64, v6, s[4:5] offset:0
global_load_dword v65, v6, s[4:5] offset:256
global_load_dword v66, v6, s[4:5] offset:512
global_load_dword v67, v6, s[4:5] offset:768
global_load_dword v68, v6, s[4:5] offset:1024
s_lshl_b32 s67, s56, 3
s_mov_b32 s66, 0
s_add_u32 m0, s59, 0
s_nop 0
buffer_load_dwordx4 v28, s[36:39], s66 offen nt lds
s_add_u32 m0, s59, 1024
s_nop 0
buffer_load_dwordx4 v29, s[36:39], s66 offen nt lds
s_add_u32 m0, s59, 2048
s_nop 0
buffer_load_dwordx4 v30, s[36:39], s66 offen nt lds
s_add_u32 m0, s59, 3072
s_add_u32 s66, s66, s67
buffer_load_dwordx4 v28, s[36:39], s66 offen nt lds
s_add_u32 m0, s59, 4096
s_nop 0
buffer_load_dwordx4 v29, s[36:39], s66 offen nt lds
s_add_u32 m0, s59, 5120
s_nop 0
buffer_load_dwordx4 v30, s[36:39], s66 offen nt lds
s_add_u32 m0, s59, 6144
s_add_u32 s66, s66, s67
buffer_load_dwordx4 v28, s[36:39], s66 offen nt lds
s_add_u32 m0, s59, 7168
s_nop 0
buffer_load_dwordx4 v29, s[36:39], s66 offen nt lds
s_add_u32 m0, s59, 8192
s_nop 0
buffer_load_dwordx4 v30, s[36:39], s66 offen nt lds
s_add_u32 m0, s59, 9216
s_add_u32 s66, s66, s67
buffer_load_dwordx4 v28, s[36:39], s66 offen nt lds
s_add_u32 m0, s59, 10240
s_nop 0
buffer_load_dwordx4 v29, s[36:39], s66 offen nt lds
s_add_u32 m0, s59, 11264
s_nop 0
buffer_load_dwordx4 v30, s[36:39], s66 offen nt lds
v_mov_b32 v12, 0
global_load_dword v3, v12, s[26:27] sc1
s_mov_b32 s44, s26
s_mov_b32 s45, s27
s_add_u32 s28, s6, s72
s_addc_u32 s29, s7, 0
s_mov_b32 s31, 0x20000
s_add_u32 s32, s8, s72
s_addc_u32 s33, s9, 0
s_lshl_b32 s14, s48, 1
s_lshr_b32 s66, s3, 2
s_mul_i32 s67, s66, 43691
s_lshr_b32 s67, s67, 17
s_mul_i32 s67, s67, 3
s_sub_u32 s66, s66, s67
s_lshl_b32 s66, s66, 5
s_add_u32 s14, s14, s66
s_mov_b32 s96, s14
s_cmp_eq_u32 s52, 1
s_addc_u32 s66, s14, s14
s_lshl_b32 s66, s66, 6
s_add_u32 s67, s66, 65
s_add_u32 s66, s66, 1
s_mul_i32 s66, s66, 43691
s_mul_i32 s67, s67, 43691
s_lshr_b32 s66, s66, 17
s_lshr_b32 s67, s67, 17
s_mul_i32 s60, s66, 384
s_sub_u32 s66, s67, s66
s_mul_i32 s67, s67, 384
s_min_u32 s30, s67, 1572864
s_cmp_eq_u32 s66, 22
s_cselect_b32 s70, -1, 0
s_bitcmp1_b32 s14, 0
s_cselect_b32 s66, 7, 1
s_add_u32 s14, s14, s66
s_cmp_ge_u32 s14, 96
s_cselect_b32 s66, 96, 0
s_sub_u32 s14, s14, s66
s_add_u32 m0, s57, 0
s_add_u32 s65, s60, 0
buffer_load_dwordx4 v220, s[28:31], s65 offen nt lds
s_add_u32 m0, s57, 1024
s_nop 0
buffer_load_dwordx4 v221, s[28:31], s65 offen nt lds
s_add_u32 m0, s57, 2048
s_nop 0
buffer_load_dwordx4 v222, s[28:31], s65 offen nt lds
s_add_u32 m0, s57, 3072
s_add_u32 s65, s60, 3072
buffer_load_dwordx4 v220, s[28:31], s65 offen nt lds
s_cmp_lt_u32 s50, 5
s_cbranch_scc0 L_w2down
s_mul_i32 s66, s49, 245760
s_lshl_b32 s67, s50, 8
s_add_u32 s66, s66, s67
s_add_u32 s40, s12, s66
s_addc_u32 s41, s13, 0
s_mov_b32 s42, 60416
s_branch L_w2done
L_w2down:
s_sub_u32 s68, s69, 5
s_mul_i32 s66, s68, 52429
s_lshr_b32 s66, s66, 18
s_mul_i32 s67, s66, 5
s_sub_u32 s67, s68, s67
s_mul_i32 s66, s66, 122880
s_lshl_b32 s67, s67, 8
s_add_u32 s66, s66, s67
s_add_u32 s40, s20, s66
s_addc_u32 s41, s21, 0
s_cmp_lt_u32 s68, 80
s_cselect_b32 s42, 60416, 0
s_cmp_lt_u32 s48, 2
s_cselect_b32 s42, s42, 0
L_w2done:
s_mul_i32 s66, s48, 61440
s_add_u32 s40, s40, s66
s_addc_u32 s41, s41, 0
s_mov_b32 s43, 0x20000
v_lshrrev_b32 v12, 2, v1
v_bfe_u32 v14, v12, 1, 2
v_mul_u32_u24 v12, 384, v12
v_and_b32 v15, 3, v1
v_lshl_add_u32 v12, v15, 3, v12
v_xor_b32 v15, 0, v14
v_lshl_add_u32 v228, v15, 5, v12
v_xor_b32 v15, 1, v14
v_lshl_add_u32 v229, v15, 5, v12
v_xor_b32 v15, 2, v14
v_lshl_add_u32 v230, v15, 5, v12
v_xor_b32 v15, 3, v14
v_lshl_add_u32 v231, v15, 5, v12
v_add_u32 v236, s59, v228
v_add_u32 v240, 6144, v236
v_add_u32 v237, s59, v229
v_add_u32 v241, 6144, v237
v_add_u32 v238, s59, v230
v_add_u32 v242, 6144, v238
v_add_u32 v239, s59, v231
v_add_u32 v243, 6144, v239
s_waitcnt vmcnt(17)
v_lshlrev_b32 v72, 16, v64
v_and_b32 v73, 0xffff0000, v64
v_lshlrev_b32 v74, 16, v65
v_and_b32 v75, 0xffff0000, v65
v_lshlrev_b32 v76, 16, v66
v_and_b32 v77, 0xffff0000, v66
v_lshlrev_b32 v78, 16, v67
v_and_b32 v79, 0xffff0000, v67
v_lshlrev_b32 v80, 16, v68
v_and_b32 v81, 0xffff0000, v68
v_add_f32 v12, v72, v73
v_add_f32 v12, v12, v74
v_add_f32 v12, v12, v75
v_add_f32 v12, v12, v76
v_add_f32 v12, v12, v77
v_add_f32 v12, v12, v78
v_add_f32 v12, v12, v79
v_add_f32 v12, v12, v80
v_add_f32 v12, v12, v81
s_nop 1
v_add_f32_dpp v12, v12, v12 quad_perm:[1,0,3,2] row_mask:0xf bank_mask:0xf
s_nop 1
v_add_f32_dpp v12, v12, v12 quad_perm:[2,3,0,1] row_mask:0xf bank_mask:0xf
s_nop 1
v_add_f32_dpp v12, v12, v12 row_half_mirror row_mask:0xf bank_mask:0xf
s_nop 1
v_add_f32_dpp v12, v12, v12 row_mirror row_mask:0xf bank_mask:0xf
v_mov_b32 v13, v12
s_nop 1
v_permlane16_swap_b32 v12, v13
v_add_f32 v12, v12, v13
v_mov_b32 v13, v12
s_nop 1
v_permlane32_swap_b32 v12, v13
v_add_f32 v12, v12, v13
v_mul_f32 v12, 0x3acccccd, v12
v_sub_f32 v13, v72, v12
v_mul_f32 v14, v13, v13
v_sub_f32 v13, v73, v12
v_fmac_f32 v14, v13, v13
v_sub_f32 v13, v74, v12
v_fmac_f32 v14, v13, v13
v_sub_f32 v13, v75, v12
v_fmac_f32 v14, v13, v13
v_sub_f32 v13, v76, v12
v_fmac_f32 v14, v13, v13
v_sub_f32 v13, v77, v12
v_fmac_f32 v14, v13, v13
v_sub_f32 v13, v78, v12
v_fmac_f32 v14, v13, v13
v_sub_f32 v13, v79, v12
v_fmac_f32 v14, v13, v13
v_sub_f32 v13, v80, v12
v_fmac_f32 v14, v13, v13
v_sub_f32 v13, v81, v12
v_fmac_f32 v14, v13, v13
s_nop 1
v_add_f32_dpp v14, v14, v14 quad_perm:[1,0,3,2] row_mask:0xf bank_mask:0xf
s_nop 1
v_add_f32_dpp v14, v14, v14 quad_perm:[2,3,0,1] row_mask:0xf bank_mask:0xf
s_nop 1
v_add_f32_dpp v14, v14, v14 row_half_mirror row_mask:0xf bank_mask:0xf
s_nop 1
v_add_f32_dpp v14, v14, v14 row_mirror row_mask:0xf bank_mask:0xf
v_mov_b32 v13, v14
s_nop 1
v_permlane16_swap_b32 v14, v13
v_add_f32 v14, v14, v13
v_mov_b32 v13, v14
s_nop 1
v_permlane32_swap_b32 v14, v13
v_add_f32 v14, v14, v13
v_mul_f32 v14, 0x3acccccd, v14
v_cvt_pk_bf16_f32 v13, v12, v14
v_lshlrev_b32 v12, 16, v13
v_and_b32 v14, 0xffff0000, v13
v_add_f32 v14, 0x3727c5ac, v14
v_cvt_pk_bf16_f32 v13, v14, v14
v_lshlrev_b32 v14, 16, v13
v_sqrt_f32 v15, v14
s_nop 0
v_rcp_f32 v16, v15
v_fma_f32 v13, -v15, v15, v14
v_mul_f32 v16, 0.5, v16
v_fma_f32 v15, v13, v16, v15
v_cvt_pk_bf16_f32 v13, v15, v15
v_lshlrev_b32 v15, 16, v13
v_rcp_f32 v16, v15
v_mov_b32 v18, v72
v_mov_b32 v19, v73
s_cmp_eq_u32 s54, 1
s_cselect_b64 vcc, -1, 0
v_cndmask_b32 v18, v18, v74, vcc
v_cndmask_b32 v19, v19, v75, vcc
s_cmp_eq_u32 s54, 2
s_cselect_b64 vcc, -1, 0
v_cndmask_b32 v18, v18, v76, vcc
v_cndmask_b32 v19, v19, v77, vcc
s_cmp_eq_u32 s54, 3
s_cselect_b64 vcc, -1, 0
v_cndmask_b32 v18, v18, v78, vcc
v_cndmask_b32 v19, v19, v79, vcc
s_cmp_eq_u32 s54, 4
s_cselect_b64 vcc, -1, 0
v_cndmask_b32 v18, v18, v80, vcc
v_cndmask_b32 v19, v19, v81, vcc
v_sub_f32 v18, v18, v12
v_sub_f32 v19, v19, v12
v_cvt_pk_bf16_f32 v13, v18, v19
v_lshlrev_b32 v18, 16, v13
v_and_b32 v19, 0xffff0000, v13
v_mul_f32 v20, v18, v16
v_fma_f32 v13, -v20, v15, v18
v_fma_f32 v20, v13, v16, v20
v_mul_f32 v21, v19, v16
v_fma_f32 v13, -v21, v15, v19
v_fma_f32 v21, v13, v16, v21
v_cvt_pk_bf16_f32 v20, v20, v21
s_lshl_b32 s66, s48, 8
s_add_u32 s66, s66, 122880
v_lshlrev_b32 v6, 2, v1
v_add_u32 v6, s66, v6
ds_write_b32 v6, v20
v_bfe_u32 v12, v1, 2, 2
v_lshlrev_b32 v12, 8, v12
v_lshrrev_b32 v13, 4, v1
v_lshl_add_u32 v12, v13, 3, v12
s_lshl_b32 s66, s48, 6
s_add_u32 s66, s66, 122880
v_add_u32 v6, s66, v12
s_waitcnt lgkmcnt(0)
s_barrier
ds_read2_b64 v[36:39], v6 offset0:0 offset1:4
s_add_u32 m0, s57, 4096
s_add_u32 s65, s60, 3072
s_waitcnt vmcnt(7)
buffer_load_dwordx4 v221, s[28:31], s65 offen nt lds
s_add_u32 m0, s57, 5120
s_waitcnt vmcnt(7)
buffer_load_dwordx4 v222, s[28:31], s65 offen nt lds
s_add_u32 m0, s57, 6144
s_add_u32 s65, s60, 6144
s_waitcnt vmcnt(7)
buffer_load_dwordx4 v220, s[28:31], s65 offen nt lds
s_add_u32 m0, s57, 7168
s_waitcnt vmcnt(7)
buffer_load_dwordx4 v221, s[28:31], s65 offen nt lds
s_waitcnt vmcnt(8) lgkmcnt(0)
ds_read_b64_tr_b16 v[64:65], v236 offset:0
ds_read_b64_tr_b16 v[66:67], v240 offset:0
ds_read_b64_tr_b16 v[68:69], v237 offset:0
ds_read_b64_tr_b16 v[70:71], v241 offset:0
ds_read_b64_tr_b16 v[72:73], v238 offset:0
ds_read_b64_tr_b16 v[74:75], v242 offset:0
ds_read_b64_tr_b16 v[76:77], v239 offset:0
ds_read_b64_tr_b16 v[78:79], v243 offset:0
ds_read_b64_tr_b16 v[80:81], v236 offset:128
ds_read_b64_tr_b16 v[82:83], v240 offset:128
s_waitcnt lgkmcnt(8)
v_mfma_f32_16x16x32_bf16 v[112:115], v[36:39], v[64:67], 0
ds_read_b64_tr_b16 v[84:85], v237 offset:128
ds_read_b64_tr_b16 v[86:87], v241 offset:128
s_waitcnt lgkmcnt(8)
v_mfma_f32_16x16x32_bf16 v[116:119], v[36:39], v[68:71], 0
ds_read_b64_tr_b16 v[88:89], v238 offset:128
ds_read_b64_tr_b16 v[90:91], v242 offset:128
s_waitcnt lgkmcnt(8)
v_mfma_f32_16x16x32_bf16 v[120:123], v[36:39], v[72:75], 0
ds_read_b64_tr_b16 v[92:93], v239 offset:128
ds_read_b64_tr_b16 v[94:95], v243 offset:128
s_waitcnt lgkmcnt(8)
v_mfma_f32_16x16x32_bf16 v[124:127], v[36:39], v[76:79], 0
ds_read_b64_tr_b16 v[96:97], v236 offset:256
ds_read_b64_tr_b16 v[98:99], v240 offset:256
s_waitcnt lgkmcnt(8)
v_mfma_f32_16x16x32_bf16 v[128:131], v[36:39], v[80:83], 0
ds_read_b64_tr_b16 v[100:101], v237 offset:256
ds_read_b64_tr_b16 v[102:103], v241 offset:256
s_waitcnt lgkmcnt(8)
v_mfma_f32_16x16x32_bf16 v[132:135], v[36:39], v[84:87], 0
ds_read_b64_tr_b16 v[104:105], v238 offset:256
ds_read_b64_tr_b16 v[106:107], v242 offset:256
s_waitcnt lgkmcnt(8)
v_mfma_f32_16x16x32_bf16 v[136:139], v[36:39], v[88:91], 0
ds_read_b64_tr_b16 v[108:109], v239 offset:256
ds_read_b64_tr_b16 v[110:111], v243 offset:256
s_waitcnt lgkmcnt(8)
v_mfma_f32_16x16x32_bf16 v[140:143], v[36:39], v[92:95], 0
s_waitcnt lgkmcnt(6)
v_mfma_f32_16x16x32_bf16 v[144:147], v[36:39], v[96:99], 0
s_waitcnt lgkmcnt(4)
v_mfma_f32_16x16x32_bf16 v[148:151], v[36:39], v[100:103], 0
s_waitcnt lgkmcnt(2)
v_mfma_f32_16x16x32_bf16 v[152:155], v[36:39], v[104:107], 0
s_waitcnt lgkmcnt(0)
v_mfma_f32_16x16x32_bf16 v[156:159], v[36:39], v[108:111], 0
s_mul_i32 s66, s48, 3072
s_add_u32 s66, s66, 124416
v_lshrrev_b32 v12, 4, v1
v_mul_u32_u24 v12, 768, v12
v_and_b32 v13, 15, v1
v_lshl_add_u32 v12, v13, 2, v12
v_add_u32 v6, s66, v12
s_nop 2
ds_write_b32 v6, v112 offset:0
ds_write_b32 v6, v116 offset:64
ds_write_b32 v6, v120 offset:128
ds_write_b32 v6, v124 offset:192
ds_write_b32 v6, v128 offset:256
ds_write_b32 v6, v132 offset:320
ds_write_b32 v6, v136 offset:384
ds_write_b32 v6, v140 offset:448
ds_write_b32 v6, v144 offset:512
ds_write_b32 v6, v148 offset:576
ds_write_b32 v6, v152 offset:640
ds_write_b32 v6, v156 offset:704
s_mul_i32 s66, s48, 768
s_add_u32 s66, s66, 124416
v_mul_u32_u24 v6, 12, v1
v_add_u32 v6, s66, v6
s_waitcnt lgkmcnt(0)
s_barrier
ds_read_b32 v64, v6 offset:0
ds_read_b32 v65, v6 offset:4
ds_read_b32 v66, v6 offset:8
ds_read_b32 v68, v6 offset:3072
ds_read_b32 v69, v6 offset:3076
ds_read_b32 v70, v6 offset:3080
ds_read_b32 v72, v6 offset:6144
ds_read_b32 v73, v6 offset:6148
ds_read_b32 v74, v6 offset:6152
ds_read_b32 v76, v6 offset:9216
ds_read_b32 v77, v6 offset:9220
ds_read_b32 v78, v6 offset:9224
v_lshrrev_b32 v12, 4, v1
v_mul_u32_u24 v12, 1280, v12
v_and_b32 v13, 15, v1
v_lshl_add_u32 v28, v13, 4, v12
s_mul_i32 s66, s53, 5
s_add_u32 s66, s66, s54
s_lshl_b32 s66, s66, 2
s_add_u32 s66, s66, s48
s_lshl_b32 s66, s66, 10
s_add_u32 s66, s66, 4096
v_add_u32 v3, 0x9e3779b9, v3
s_waitcnt lgkmcnt(0)
v_add_f32 v64, v64, v68
v_add_f32 v72, v72, v76
v_add_f32 v65, v65, v69
v_add_f32 v73, v73, v77
v_add_f32 v66, v66, v70
v_add_f32 v74, v74, v78
v_add_f32 v64, v64, v72
v_add_f32 v65, v65, v73
v_add_f32 v66, v66, v74
v_mov_b32 v67, v3
s_cmp_eq_u32 s55, 0
s_cbranch_scc1 L_nopub1
buffer_store_dwordx4 v[64:67], v2, s[44:47], s66 offen sc1
L_nopub1:
s_add_u32 m0, s57, 8192
s_add_u32 s65, s60, 6144
s_waitcnt vmcnt(7)
buffer_load_dwordx4 v222, s[28:31], s65 offen nt lds
s_mov_b32 s66, 0
s_add_u32 m0, s59, 0
s_waitcnt vmcnt(7)
buffer_load_dwordx4 v28, s[40:43], s66 offen nt lds
s_add_u32 s66, s66, 5120
s_add_u32 m0, s59, 1024
s_waitcnt vmcnt(7)
buffer_load_dwordx4 v28, s[40:43], s66 offen nt lds
s_add_u32 s66, s66, 5120
s_add_u32 m0, s59, 2048
s_waitcnt vmcnt(7)
buffer_load_dwordx4 v28, s[40:43], s66 offen nt lds
s_add_u32 s66, s66, 5120
s_add_u32 m0, s59, 3072
s_waitcnt vmcnt(7)
buffer_load_dwordx4 v28, s[40:43], s66 offen nt lds
s_add_u32 s66, s66, 5120
s_add_u32 m0, s59, 4096
s_waitcnt vmcnt(7)
buffer_load_dwordx4 v28, s[40:43], s66 offen nt lds
s_add_u32 s66, s66, 5120
s_add_u32 m0, s59, 5120
s_waitcnt vmcnt(7)
buffer_load_dwordx4 v28, s[40:43], s66 offen nt lds
s_add_u32 s66, s66, 5120
s_add_u32 m0, s59, 6144
s_waitcnt vmcnt(7)
buffer_load_dwordx4 v28, s[40:43], s66 offen nt lds
s_add_u32 s66, s66, 5120
s_add_u32 m0, s59, 7168
s_waitcnt vmcnt(7)
buffer_load_dwordx4 v28, s[40:43], s66 offen nt lds
s_add_u32 s66, s66, 5120
s_add_u32 m0, s59, 8192
s_waitcnt vmcnt(7)
buffer_load_dwordx4 v28, s[40:43], s66 offen nt lds
s_add_u32 s66, s66, 5120
s_add_u32 m0, s59, 9216
s_waitcnt vmcnt(7)
buffer_load_dwordx4 v28, s[40:43], s66 offen nt lds
v_mov_b32 v12, 137888
v_mov_b32 v13, 4
ds_write_b32 v12, v13
s_add_u32 s66, s66, 5120
s_add_u32 m0, s59, 10240
s_waitcnt vmcnt(7)
buffer_load_dwordx4 v28, s[40:43], s66 offen nt lds
s_add_u32 s66, s66, 5120
s_add_u32 m0, s59, 11264
s_waitcnt vmcnt(7)
buffer_load_dwordx4 v28, s[40:43], s66 offen nt lds
s_cmp_eq_u32 s52, 1
s_addc_u32 s66, s14, s14
s_lshl_b32 s66, s66, 6
s_add_u32 s67, s66, 65
s_add_u32 s66, s66, 1
s_mul_i32 s66, s66, 43691
s_mul_i32 s67, s67, 43691
s_lshr_b32 s66, s66, 17
s_lshr_b32 s67, s67, 17
s_mul_i32 s60, s66, 384
s_sub_u32 s66, s67, s66
s_mul_i32 s67, s67, 384
s_min_u32 s30, s67, 1572864
s_cmp_eq_u32 s66, 22
s_cselect_b32 s71, -1, 0
s_bitcmp1_b32 s14, 0
s_cselect_b32 s66, 7, 1
s_add_u32 s14, s14, s66
s_cmp_ge_u32 s14, 96
s_cselect_b32 s66, 96, 0
s_sub_u32 s14, s14, s66
s_add_u32 m0, s58, 0
s_add_u32 s65, s60, 0
s_waitcnt vmcnt(7)
buffer_load_dwordx4 v220, s[28:31], s65 offen nt lds
s_add_u32 m0, s58, 1024
s_waitcnt vmcnt(7)
buffer_load_dwordx4 v221, s[28:31], s65 offen nt lds
s_add_u32 m0, s58, 2048
s_waitcnt vmcnt(7)
buffer_load_dwordx4 v222, s[28:31], s65 offen nt lds
s_add_u32 m0, s58, 3072
s_add_u32 s65, s60, 3072
s_waitcnt vmcnt(7)
buffer_load_dwordx4 v220, s[28:31], s65 offen nt lds
s_add_u32 m0, s58, 4096
s_waitcnt vmcnt(7)
buffer_load_dwordx4 v221, s[28:31], s65 offen nt lds
s_add_u32 m0, s58, 5120
s_waitcnt vmcnt(7)
buffer_load_dwordx4 v222, s[28:31], s65 offen nt lds
s_add_u32 m0, s58, 6144
s_add_u32 s65, s60, 6144
s_waitcnt vmcnt(7)
buffer_load_dwordx4 v220, s[28:31], s65 offen nt lds
s_add_u32 m0, s58, 7168
s_waitcnt vmcnt(7)
buffer_load_dwordx4 v221, s[28:31], s65 offen nt lds
s_add_u32 m0, s58, 8192
s_waitcnt vmcnt(7)
buffer_load_dwordx4 v222, s[28:31], s65 offen nt lds
v_mov_b32 v112, 0
v_mov_b32 v113, 0
v_mov_b32 v114, 0
v_mov_b32 v115, 0
v_mov_b32 v116, 0
v_mov_b32 v117, 0
v_mov_b32 v118, 0
v_mov_b32 v119, 0
v_mov_b32 v120, 0
v_mov_b32 v121, 0
v_mov_b32 v122, 0
v_mov_b32 v123, 0
v_mov_b32 v124, 0
v_mov_b32 v125, 0
v_mov_b32 v126, 0
v_mov_b32 v127, 0
v_mov_b32 v128, 0
v_mov_b32 v129, 0
v_mov_b32 v130, 0
v_mov_b32 v131, 0
v_mov_b32 v132, 0
v_mov_b32 v133, 0
v_mov_b32 v134, 0
v_mov_b32 v135, 0
v_mov_b32 v136, 0
v_mov_b32 v137, 0
v_mov_b32 v138, 0
v_mov_b32 v139, 0
v_mov_b32 v140, 0
v_mov_b32 v141, 0
v_mov_b32 v142, 0
v_mov_b32 v143, 0
v_mov_b32 v144, 0
v_mov_b32 v145, 0
v_mov_b32 v146, 0
v_mov_b32 v147, 0
v_mov_b32 v148, 0
v_mov_b32 v149, 0
v_mov_b32 v150, 0
v_mov_b32 v151, 0
v_mov_b32 v152, 0
v_mov_b32 v153, 0
v_mov_b32 v154, 0
v_mov_b32 v155, 0
v_mov_b32 v156, 0
v_mov_b32 v157, 0
v_mov_b32 v158, 0
v_mov_b32 v159, 0
v_mov_b32 v7, 0xf149f2ca
v_mov_b32 v8, 0xf149f2ca
v_mov_b32 v9, 0
s_mov_b32 s34, 0xff80ff80
v_lshrrev_b32 v13, 4, v1
v_and_b32 v12, 15, v1
v_and_b32 v14, 6, v12
v_xor_b32 v14, v14, v13
v_mul_u32_u24 v12, 384, v12
v_lshl_add_u32 v224, v14, 4, v12
v_xor_b32 v14, 4, v14
v_lshl_add_u32 v225, v14, 4, v12
v_and_b32 v12, 15, v1
v_min_u32 v12, 5, v12
v_add_u32 v12, 16, v12
v_and_b32 v14, 6, v12
v_xor_b32 v14, v14, v13
v_mul_u32_u24 v12, 384, v12
v_lshl_add_u32 v226, v14, 4, v12
v_xor_b32 v14, 4, v14
v_lshl_add_u32 v227, v14, 4, v12
v_lshrrev_b32 v12, 2, v1
v_min_u32 v12, 5, v12
v_add_u32 v12, 16, v12
v_bfe_u32 v14, v12, 1, 2
v_mul_u32_u24 v12, 384, v12
v_and_b32 v15, 3, v1
v_lshl_add_u32 v12, v15, 3, v12
v_xor_b32 v15, 0, v14
v_lshl_add_u32 v232, v15, 5, v12
v_xor_b32 v15, 1, v14
v_lshl_add_u32 v233, v15, 5, v12
v_xor_b32 v15, 2, v14
v_lshl_add_u32 v234, v15, 5, v12
v_xor_b32 v15, 3, v14
v_lshl_add_u32 v235, v15, 5, v12
v_cmp_gt_u32 vcc, 16, v1
v_mov_b32 v12, 0xffff
v_mov_b32 v14, 0xffff0000
v_cndmask_b32 v214, 0, -1, vcc
v_cmp_eq_u32 vcc, 1, v13
s_mul_i32 s66, s48, 1536
s_add_u32 s66, s66, 137920
v_cndmask_b32 v212, v214, v12, vcc
v_cndmask_b32 v213, 0, v14, vcc
v_lshl_add_u32 v215, v13, 4, s66
v_add_u32 v216, 1408, v215
v_mov_b32 v217, 137872
v_mov_b32 v218, 1
v_add_u32 v12, 352, v1
v_cmp_gt_u32 vcc, 32, v1
v_add_u32 v14, -32, v1
s_nop 0
v_cndmask_b32 v12, v14, v12, vcc
v_lshl_add_u32 v219, v12, 2, s66
s_add_u32 s35, s66, 128
v_lshlrev_b32 v6, 4, v13
v_add_u32 v6, 136704, v6
v_mov_b32 v14, 137856
s_waitcnt vmcnt(9)
s_barrier
ds_read_b64 v[16:17], v14
ds_read_b128 v[40:43], v6 offset:0
ds_read_b128 v[44:47], v6 offset:64
ds_read_b128 v[48:51], v6 offset:128
ds_read_b128 v[52:55], v6 offset:192
ds_read_b128 v[56:59], v6 offset:256
ds_read_b128 v[60:63], v6 offset:320
s_mov_b32 s61, 0
s_waitcnt lgkmcnt(6)
v_readfirstlane_b32 s73, v16
v_readfirstlane_b32 s72, v17
s_nop 0
s_mov_b64 s[94:95], 0
s_bitcmp1_b32 s73, 0
s_cselect_b32 s66, 0x3f, 0
s_or_b32 s94, s94, s66
s_bitcmp1_b32 s72, 0
s_cselect_b32 s66, 0xfc000000, 0
s_or_b32 s94, s94, s66
s_bitcmp1_b32 s73, 1
s_cselect_b32 s66, 0x3fc0, 0
s_or_b32 s94, s94, s66
s_bitcmp1_b32 s72, 1
s_cselect_b32 s67, 0xff, 0
s_or_b32 s95, s95, s67
s_bitcmp1_b32 s73, 2
s_cselect_b32 s66, 0xfc000, 0
s_or_b32 s94, s94, s66
s_bitcmp1_b32 s72, 2
s_cselect_b32 s67, 0x3f00, 0
s_or_b32 s95, s95, s67
s_bitcmp1_b32 s3, 0
s_cselect_b32 s66, s72, s73
s_bitcmp1_b32 s66, 2
s_cselect_b32 s66, 0x500000, 0
s_or_b32 s94, s94, s66
s_bitcmp1_b32 s3, 0
s_cselect_b32 s66, s73, s72
s_bitcmp1_b32 s66, 2
s_cselect_b32 s66, 0xa00000, 0
s_or_b32 s94, s94, s66
s_sub_u32 s66, 0, s52
s_xor_b32 s94, s94, s66
s_xor_b32 s95, s95, s66
s_mov_b32 s15, 4
s_waitcnt lgkmcnt(0)
.p2align 6
L_kloop:
v_add_u32 v236, s57, v224
v_add_u32 v237, s57, v225
v_add_u32 v238, s57, v226
v_add_u32 v239, s57, v227
s_waitcnt vmcnt(9)
s_mov_b64 exec, 1
ds_add_u32 v217, v218
s_mov_b64 exec, -1
ds_read_b128 v[64:67], v236 offset:0
ds_read_b128 v[68:71], v237 offset:0
ds_read_b128 v[72:75], v236 offset:128
ds_read_b128 v[76:79], v237 offset:128
ds_read_b128 v[80:83], v236 offset:256
ds_read_b128 v[84:87], v237 offset:256
ds_read_b128 v[88:91], v238 offset:0
ds_read_b128 v[92:95], v239 offset:0
ds_read_b128 v[96:99], v238 offset:128
ds_read_b128 v[100:103], v239 offset:128
ds_read_b128 v[104:107], v238 offset:256
ds_read_b128 v[108:111], v239 offset:256
ds_read_b128 v[208:211], v217
v_and_or_b32 v20, v213, s70, v212
s_mov_b32 s70, s71
s_cmp_lg_u32 s61, 22
s_cbranch_scc1 L_knosw
s_mov_b32 s28, s32
s_mov_b32 s29, s33
s_cmp_ge_u32 s96, 8
s_cselect_b32 s14, -8, 88
s_add_u32 s14, s14, s96
L_knosw:
s_bitcmp1_b64 s[94:95], s61
s_addc_u32 s66, s14, s14
s_lshl_b32 s66, s66, 6
s_add_u32 s67, s66, 65
s_add_u32 s66, s66, 1
s_mul_i32 s66, s66, 43691
s_mul_i32 s67, s67, 43691
s_lshr_b32 s66, s66, 17
s_lshr_b32 s67, s67, 17
s_mul_i32 s60, s66, 384
s_sub_u32 s66, s67, s66
s_mul_i32 s67, s67, 384
s_min_u32 s30, s67, 1572864
s_cmp_eq_u32 s66, 22
s_cselect_b32 s71, -1, 0
s_bitcmp1_b32 s14, 0
s_cselect_b32 s66, 7, 1
s_add_u32 s14, s14, s66
s_cmp_ge_u32 s14, 96
s_cselect_b32 s66, 96, 0
s_sub_u32 s14, s14, s66
s_waitcnt lgkmcnt(12)
v_mfma_f32_16x16x32_bf16 v[28:31], v[64:67], v[40:43], 0
s_waitcnt lgkmcnt(11)
v_mfma_f32_16x16x32_bf16 v[28:31], v[68:71], v[44:47], v[28:31]
s_waitcnt lgkmcnt(10)
v_mfma_f32_16x16x32_bf16 v[28:31], v[72:75], v[48:51], v[28:31]
s_waitcnt lgkmcnt(9)
v_mfma_f32_16x16x32_bf16 v[28:31], v[76:79], v[52:55], v[28:31]
s_waitcnt lgkmcnt(8)
v_mfma_f32_16x16x32_bf16 v[28:31], v[80:83], v[56:59], v[28:31]
s_waitcnt lgkmcnt(7)
v_mfma_f32_16x16x32_bf16 v[28:31], v[84:87], v[60:63], v[28:31]
s_waitcnt lgkmcnt(6)
v_mfma_f32_16x16x32_bf16 v[32:35], v[88:91], v[40:43], 0
s_waitcnt lgkmcnt(5)
v_mfma_f32_16x16x32_bf16 v[32:35], v[92:95], v[44:47], v[32:35]
s_waitcnt lgkmcnt(4)
v_mfma_f32_16x16x32_bf16 v[32:35], v[96:99], v[48:51], v[32:35]
s_waitcnt lgkmcnt(3)
v_mfma_f32_16x16x32_bf16 v[32:35], v[100:103], v[52:55], v[32:35]
s_waitcnt lgkmcnt(2)
v_mfma_f32_16x16x32_bf16 v[32:35], v[104:107], v[56:59], v[32:35]
s_waitcnt lgkmcnt(1)
v_mfma_f32_16x16x32_bf16 v[32:35], v[108:111], v[60:63], v[32:35]
L_ks:
s_waitcnt lgkmcnt(0)
v_readfirstlane_b32 s66, v208
s_nop 0
s_cmp_ge_u32 s66, s15
s_cbranch_scc1 L_ks_ok
ds_read_b128 v[208:211], v217
s_branch L_ks
L_ks_ok:
s_add_u32 m0, s57, 0
s_add_u32 s65, s60, 0
buffer_load_dwordx4 v220, s[28:31], s65 offen nt lds
s_nop 4
v_cvt_pk_bf16_f32 v12, v28, v29
v_lshlrev_b32 v28, 16, v12
v_and_b32 v29, 0xffff0000, v12
v_cvt_pk_bf16_f32 v13, v30, v31
v_lshlrev_b32 v30, 16, v13
v_and_b32 v31, 0xffff0000, v13
v_cvt_pk_bf16_f32 v14, v32, v33
v_lshlrev_b32 v32, 16, v14
v_and_b32 v33, 0xffff0000, v14
v_cvt_pk_bf16_f32 v15, v34, v35
v_lshlrev_b32 v34, 16, v15
v_and_b32 v35, 0xffff0000, v15
v_mul_f32 v28, s63, v28
v_mul_f32 v29, s63, v29
v_mul_f32 v30, s63, v30
v_mul_f32 v31, s63, v31
v_mul_f32 v32, s63, v32
v_mul_f32 v33, s63, v33
v_mul_f32 v34, s63, v34
v_mul_f32 v35, s63, v35
v_cvt_pk_bf16_f32 v12, v28, v29
v_cvt_pk_bf16_f32 v13, v30, v31
v_cvt_pk_bf16_f32 v14, v32, v33
v_cvt_pk_bf16_f32 v15, v34, v35
v_bfi_b32 v14, v20, v14, s34
v_bfi_b32 v15, v214, v15, s34
s_mov_b32 exec_lo, 0x00010001
s_mov_b32 exec_hi, 0x00010001
ds_write_b128 v215, v[12:15]
s_mov_b64 exec, -1
v_add_u32 v215, 64, v215
s_cmp_eq_u32 s61, 23
s_cbranch_scc1 L_spa
s_add_u32 m0, s57, 1024
s_add_u32 s65, s60, 0
s_waitcnt vmcnt(6)
buffer_load_dwordx4 v221, s[28:31], s65 offen nt lds
s_add_u32 m0, s57, 2048
s_waitcnt vmcnt(6)
buffer_load_dwordx4 v222, s[28:31], s65 offen nt lds
s_add_u32 m0, s57, 3072
s_add_u32 s65, s60, 3072
s_waitcnt vmcnt(6)
buffer_load_dwordx4 v220, s[28:31], s65 offen nt lds
s_add_u32 m0, s57, 4096
s_waitcnt vmcnt(6)
buffer_load_dwordx4 v221, s[28:31], s65 offen nt lds
s_add_u32 m0, s57, 5120
s_waitcnt vmcnt(6)
buffer_load_dwordx4 v222, s[28:31], s65 offen nt lds
s_add_u32 m0, s57, 6144
s_add_u32 s65, s60, 6144
s_waitcnt vmcnt(6)
buffer_load_dwordx4 v220, s[28:31], s65 offen nt lds
s_add_u32 m0, s57, 7168
s_waitcnt vmcnt(6)
buffer_load_dwordx4 v221, s[28:31], s65 offen nt lds
s_add_u32 m0, s57, 8192
s_waitcnt vmcnt(6)
buffer_load_dwordx4 v222, s[28:31], s65 offen nt lds
L_kpe:
s_mov_b32 s66, s57
s_mov_b32 s57, s58
s_mov_b32 s58, s66
s_add_u32 s61, s61, 1
s_add_u32 s15, s15, 4
s_branch L_kloop
.p2align 6
L_vloop:
v_add_u32 v236, s57, v228
v_add_u32 v237, s57, v229
v_add_u32 v238, s57, v230
v_add_u32 v239, s57, v231
v_add_u32 v240, s57, v232
v_add_u32 v241, s57, v233
v_add_u32 v242, s57, v234
v_add_u32 v243, s57, v235
ds_read_b128 v[36:39], v216
s_cmp_eq_u32 s61, 25
s_cselect_b32 s66, -1472, 64
v_add_u32 v216, s66, v216
s_cmp_lg_u32 s61, 24
s_cbranch_scc1 L_vnosw
s_mov_b32 s14, s96
L_vnosw:
s_bitcmp1_b64 s[94:95], s61
s_addc_u32 s66, s14, s14
s_lshl_b32 s66, s66, 6
s_add_u32 s67, s66, 65
s_add_u32 s66, s66, 1
s_mul_i32 s66, s66, 43691
s_mul_i32 s67, s67, 43691
s_lshr_b32 s66, s66, 17
s_lshr_b32 s67, s67, 17
s_mul_i32 s60, s66, 384
s_sub_u32 s66, s67, s66
s_mul_i32 s67, s67, 384
s_min_u32 s30, s67, 1572864
s_cmp_ge_u32 s61, 46
s_cselect_b32 s30, 0, s30
s_bitcmp1_b32 s14, 0
s_cselect_b32 s66, 7, 1
s_add_u32 s14, s14, s66
s_cmp_ge_u32 s14, 96
s_cselect_b32 s66, 96, 0
s_sub_u32 s14, s14, s66
s_waitcnt vmcnt(9)
s_mov_b64 exec, 1
ds_add_u32 v217, v218
s_mov_b64 exec, -1
ds_read_b64_tr_b16 v[64:65], v236 offset:0
ds_read_b64_tr_b16 v[66:67], v240 offset:0
ds_read_b64_tr_b16 v[68:69], v237 offset:0
ds_read_b64_tr_b16 v[70:71], v241 offset:0
ds_read_b64_tr_b16 v[72:73], v238 offset:0
ds_read_b64_tr_b16 v[74:75], v242 offset:0
ds_read_b64_tr_b16 v[76:77], v239 offset:0
ds_read_b64_tr_b16 v[78:79], v243 offset:0
ds_read_b64_tr_b16 v[80:81], v236 offset:128
ds_read_b64_tr_b16 v[82:83], v240 offset:128
s_waitcnt lgkmcnt(8)
v_mfma_f32_16x16x32_bf16 v[112:115], v[36:39], v[64:67], v[112:115]
ds_read_b64_tr_b16 v[84:85], v237 offset:128
ds_read_b64_tr_b16 v[86:87], v241 offset:128
s_waitcnt lgkmcnt(8)
v_mfma_f32_16x16x32_bf16 v[116:119], v[36:39], v[68:71], v[116:119]
ds_read_b64_tr_b16 v[88:89], v238 offset:128
ds_read_b64_tr_b16 v[90:91], v242 offset:128
s_waitcnt lgkmcnt(8)
v_mfma_f32_16x16x32_bf16 v[120:123], v[36:39], v[72:75], v[120:123]
ds_read_b64_tr_b16 v[92:93], v239 offset:128
ds_read_b64_tr_b16 v[94:95], v243 offset:128
s_waitcnt lgkmcnt(8)
v_mfma_f32_16x16x32_bf16 v[124:127], v[36:39], v[76:79], v[124:127]
ds_read_b64_tr_b16 v[96:97], v236 offset:256
ds_read_b64_tr_b16 v[98:99], v240 offset:256
s_waitcnt lgkmcnt(8)
v_mfma_f32_16x16x32_bf16 v[128:131], v[36:39], v[80:83], v[128:131]
ds_read_b64_tr_b16 v[100:101], v237 offset:256
ds_read_b64_tr_b16 v[102:103], v241 offset:256
s_waitcnt lgkmcnt(8)
v_mfma_f32_16x16x32_bf16 v[132:135], v[36:39], v[84:87], v[132:135]
ds_read_b64_tr_b16 v[104:105], v238 offset:256
ds_read_b64_tr_b16 v[106:107], v242 offset:256
s_waitcnt lgkmcnt(8)
v_mfma_f32_16x16x32_bf16 v[136:139], v[36:39], v[88:91], v[136:139]
ds_read_b64_tr_b16 v[108:109], v239 offset:256
ds_read_b64_tr_b16 v[110:111], v243 offset:256
ds_read_b128 v[208:211], v217
s_waitcnt lgkmcnt(9)
v_mfma_f32_16x16x32_bf16 v[140:143], v[36:39], v[92:95], v[140:143]
s_waitcnt lgkmcnt(7)
v_mfma_f32_16x16x32_bf16 v[144:147], v[36:39], v[96:99], v[144:147]
s_waitcnt lgkmcnt(5)
v_mfma_f32_16x16x32_bf16 v[148:151], v[36:39], v[100:103], v[148:151]
s_waitcnt lgkmcnt(3)
v_mfma_f32_16x16x32_bf16 v[152:155], v[36:39], v[104:107], v[152:155]
s_waitcnt lgkmcnt(1)
v_mfma_f32_16x16x32_bf16 v[156:159], v[36:39], v[108:111], v[156:159]
s_cmp_eq_u32 s61, 47
s_cbranch_scc1 L_loopx
L_vs:
s_waitcnt lgkmcnt(0)
v_readfirstlane_b32 s66, v208
s_nop 0
s_cmp_ge_u32 s66, s15
s_cbranch_scc1 L_vs_ok
ds_read_b128 v[208:211], v217
s_branch L_vs
L_vs_ok:
s_add_u32 m0, s57, 0
s_add_u32 s65, s60, 0
buffer_load_dwordx4 v220, s[28:31], s65 offen nt lds
s_cmp_eq_u32 s61, 27
s_cbranch_scc1 L_spb
L_vmid:
v_readfirstlane_b32 s67, v210
s_nop 0
s_cmp_ge_u32 s61, 42
s_cbranch_scc0 L_vpc
s_add_u32 m0, s57, 1024
s_add_u32 s65, s60, 0
buffer_load_dwordx4 v221, s[28:31], s65 offen nt lds
s_add_u32 m0, s57, 2048
s_nop 0
buffer_load_dwordx4 v222, s[28:31], s65 offen nt lds
s_add_u32 m0, s57, 3072
s_add_u32 s65, s60, 3072
buffer_load_dwordx4 v220, s[28:31], s65 offen nt lds
s_add_u32 m0, s57, 4096
s_nop 0
buffer_load_dwordx4 v221, s[28:31], s65 offen nt lds
s_add_u32 m0, s57, 5120
s_nop 0
buffer_load_dwordx4 v222, s[28:31], s65 offen nt lds
s_add_u32 m0, s57, 6144
s_add_u32 s65, s60, 6144
buffer_load_dwordx4 v220, s[28:31], s65 offen nt lds
s_add_u32 m0, s57, 7168
s_nop 0
buffer_load_dwordx4 v221, s[28:31], s65 offen nt lds
s_add_u32 m0, s57, 8192
s_nop 0
buffer_load_dwordx4 v222, s[28:31], s65 offen nt lds
s_branch L_vpe
L_vpc:
s_cmp_gt_i32 s67, s61
s_cbranch_scc1 L_vup
s_add_u32 m0, s57, 1024
s_add_u32 s65, s60, 0
s_waitcnt vmcnt(6)
buffer_load_dwordx4 v221, s[28:31], s65 offen nt lds
s_add_u32 m0, s57, 2048
s_waitcnt vmcnt(6)
buffer_load_dwordx4 v222, s[28:31], s65 offen nt lds
s_add_u32 m0, s57, 3072
s_add_u32 s65, s60, 3072
s_waitcnt vmcnt(6)
buffer_load_dwordx4 v220, s[28:31], s65 offen nt lds
s_add_u32 m0, s57, 4096
s_waitcnt vmcnt(6)
buffer_load_dwordx4 v221, s[28:31], s65 offen nt lds
s_add_u32 m0, s57, 5120
s_waitcnt vmcnt(6)
buffer_load_dwordx4 v222, s[28:31], s65 offen nt lds
s_add_u32 m0, s57, 6144
s_add_u32 s65, s60, 6144
s_waitcnt vmcnt(6)
buffer_load_dwordx4 v220, s[28:31], s65 offen nt lds
s_add_u32 m0, s57, 7168
s_waitcnt vmcnt(6)
buffer_load_dwordx4 v221, s[28:31], s65 offen nt lds
s_add_u32 m0, s57, 8192
s_waitcnt vmcnt(6)
buffer_load_dwordx4 v222, s[28:31], s65 offen nt lds
L_vpe:
s_mov_b32 s66, s57
s_mov_b32 s57, s58
s_mov_b32 s58, s66
s_add_u32 s61, s61, 1
s_add_u32 s15, s15, 4
s_branch L_vloop
L_loopx:
s_mov_b64 exec, 0xffff
s_nop 3
ds_write_b32 v215, v112 offset:0
ds_write_b32 v215, v116 offset:64
ds_write_b32 v215, v120 offset:128
ds_write_b32 v215, v124 offset:192
ds_write_b32 v215, v128 offset:256
ds_write_b32 v215, v132 offset:320
ds_write_b32 v215, v136 offset:384
ds_write_b32 v215, v140 offset:448
ds_write_b32 v215, v144 offset:512
ds_write_b32 v215, v148 offset:576
ds_write_b32 v215, v152 offset:640
ds_write_b32 v215, v156 offset:704
s_mov_b64 exec, -1
s_waitcnt lgkmcnt(0)
s_barrier
s_cmp_ge_u32 s50, 5
s_cbranch_scc1 L_sdone
s_lshl_b32 s66, s49, 3
s_lshl_b32 s67, s48, 1
s_add_u32 s66, s66, s67
s_lshl_b32 s66, s66, 11
s_add_u32 s66, s66, 1048576
s_add_u32 s67, s66, 2048
v_mov_b32 v6, 1024
s_mul_i32 s68, s48, 384
s_add_u32 s68, s68, 122880
v_mul_u32_u24 v236, 6, v1
v_add_u32 v236, s68, v236
v_bfe_u32 v14, v1, 2, 2
v_mul_u32_u24 v14, 384, v14
v_lshrrev_b32 v15, 4, v1
v_lshl_add_u32 v14, v15, 3, v14
v_add_u32 v237, 122880, v14
s_lshl_b32 s70, s50, 2
s_add_u32 s70, s70, s48
s_lshl_b32 s70, s70, 5
s_add_u32 s70, s70, s49
s_lshl_b32 s70, s70, 10
s_add_u32 s70, s70, 2097152
s_mov_b32 s62, 32768
L_po:
buffer_load_dwordx4 v[64:67], v2, s[44:47], s66 offen sc1
buffer_load_dwordx4 v[68:71], v2, s[44:47], s67 offen sc1
buffer_load_dwordx4 v[72:75], v6, s[44:47], s66 offen sc1
buffer_load_dwordx4 v[76:79], v6, s[44:47], s67 offen sc1
s_waitcnt vmcnt(0)
v_xor_b32 v12, v67, v3
v_xor_b32 v13, v71, v3
v_or_b32 v12, v12, v13
v_xor_b32 v13, v75, v3
v_or_b32 v12, v12, v13
v_xor_b32 v13, v79, v3
v_or_b32 v12, v12, v13
v_cmp_ne_u32 vcc, 0, v12
s_cbranch_vccz L_po_ok
s_sub_u32 s62, s62, 1
s_cmp_lg_u32 s62, 0
s_cbranch_scc1 L_po
v_mov_b32 v12, 0
v_mov_b32 v13, 4
global_store_dword v12, v13, s[24:25]
L_po_ok:
v_max_f32 v12, v72, v76
v_sub_f32 v40, v72, v12
v_sub_f32 v41, v76, v12
v_exp_f32 v40, v40
v_exp_f32 v41, v41
s_nop 0
v_mul_f32 v42, v73, v40
v_fmac_f32 v42, v77, v41
v_rcp_f32 v43, v42
v_mul_f32 v44, v64, v40
v_fmac_f32 v44, v68, v41
v_mul_f32 v45, v65, v40
v_fmac_f32 v45, v69, v41
v_mul_f32 v46, v66, v40
v_fmac_f32 v46, v70, v41
v_mul_f32 v48, v44, v43
v_fma_f32 v12, -v48, v42, v44
v_fma_f32 v48, v12, v43, v48
v_mul_f32 v49, v45, v43
v_fma_f32 v12, -v49, v42, v45
v_fma_f32 v49, v12, v43, v49
v_mul_f32 v50, v46, v43
v_fma_f32 v12, -v50, v42, v46
v_fma_f32 v50, v12, v43, v50
v_cvt_pk_bf16_f32 v12, v48, v49
v_cvt_pk_bf16_f32 v13, v50, v50
ds_write_b16 v236, v12
ds_write_b16_d16_hi v236, v12 offset:2
ds_write_b16 v236, v13 offset:4
s_waitcnt lgkmcnt(0)
s_barrier
ds_read2_b64 v[112:115], v237 offset0:0 offset1:4
ds_read2_b64 v[116:119], v237 offset0:8 offset1:12
ds_read2_b64 v[120:123], v237 offset0:16 offset1:20
ds_read2_b64 v[124:127], v237 offset0:24 offset1:28
ds_read2_b64 v[128:131], v237 offset0:32 offset1:36
ds_read2_b64 v[132:135], v237 offset0:40 offset1:44
s_waitcnt lgkmcnt(5)
v_mfma_f32_16x16x32_bf16 v[28:31], v[112:115], v[160:163], 0
v_mfma_f32_16x16x32_bf16 v[32:35], v[112:115], v[184:187], 0
s_waitcnt lgkmcnt(4)
v_mfma_f32_16x16x32_bf16 v[28:31], v[116:119], v[164:167], v[28:31]
v_mfma_f32_16x16x32_bf16 v[32:35], v[116:119], v[188:191], v[32:35]
s_waitcnt lgkmcnt(3)
v_mfma_f32_16x16x32_bf16 v[28:31], v[120:123], v[168:171], v[28:31]
v_mfma_f32_16x16x32_bf16 v[32:35], v[120:123], v[192:195], v[32:35]
s_waitcnt lgkmcnt(2)
v_mfma_f32_16x16x32_bf16 v[28:31], v[124:127], v[172:175], v[28:31]
v_mfma_f32_16x16x32_bf16 v[32:35], v[124:127], v[196:199], v[32:35]
s_waitcnt lgkmcnt(1)
v_mfma_f32_16x16x32_bf16 v[28:31], v[128:131], v[176:179], v[28:31]
v_mfma_f32_16x16x32_bf16 v[32:35], v[128:131], v[200:203], v[32:35]
s_waitcnt lgkmcnt(0)
v_mfma_f32_16x16x32_bf16 v[28:31], v[132:135], v[180:183], v[28:31]
v_mfma_f32_16x16x32_bf16 v[32:35], v[132:135], v[204:207], v[32:35]
v_mov_b32 v14, v3
v_mov_b32 v15, v3
s_nop 5
v_mov_b32 v12, v28
v_mov_b32 v13, v32
buffer_store_dwordx4 v[12:15], v2, s[44:47], s70 offen sc1
L_sdone:
s_endpgm
L_vup:
s_add_u32 m0, s57, 1024
s_add_u32 s65, s60, 0
s_waitcnt vmcnt(11)
buffer_load_dwordx4 v221, s[28:31], s65 offen nt lds
s_add_u32 m0, s57, 2048
s_waitcnt vmcnt(11)
buffer_load_dwordx4 v222, s[28:31], s65 offen nt lds
s_add_u32 m0, s57, 3072
s_add_u32 s65, s60, 3072
s_waitcnt vmcnt(11)
buffer_load_dwordx4 v220, s[28:31], s65 offen nt lds
s_add_u32 m0, s57, 4096
s_waitcnt vmcnt(11)
buffer_load_dwordx4 v221, s[28:31], s65 offen nt lds
s_add_u32 m0, s57, 5120
s_waitcnt vmcnt(11)
buffer_load_dwordx4 v222, s[28:31], s65 offen nt lds
s_add_u32 m0, s57, 6144
s_add_u32 s65, s60, 6144
s_waitcnt vmcnt(11)
buffer_load_dwordx4 v220, s[28:31], s65 offen nt lds
s_add_u32 m0, s57, 7168
s_waitcnt vmcnt(11)
buffer_load_dwordx4 v221, s[28:31], s65 offen nt lds
s_add_u32 m0, s57, 8192
s_waitcnt vmcnt(11)
buffer_load_dwordx4 v222, s[28:31], s65 offen nt lds
s_branch L_vpe
L_spa:
ds_read_b32 v20, v219 offset:0
s_waitcnt lgkmcnt(0)
v_lshlrev_b32 v64, 16, v20
v_and_b32 v65, 0xffff0000, v20
v_max3_f32 v7, v64, v65, v7
s_nop 1
v_max_f32_dpp v7, v7, v7 quad_perm:[1,0,3,2] row_mask:0xf bank_mask:0xf
s_nop 1
v_max_f32_dpp v7, v7, v7 quad_perm:[2,3,0,1] row_mask:0xf bank_mask:0xf
s_nop 1
v_max_f32_dpp v7, v7, v7 row_half_mirror row_mask:0xf bank_mask:0xf
s_nop 1
v_max_f32_dpp v7, v7, v7 row_mirror row_mask:0xf bank_mask:0xf
v_mov_b32 v12, v7
s_nop 1
v_permlane16_swap_b32 v7, v12
v_max_f32 v7, v7, v12
v_mov_b32 v12, v7
s_nop 1
v_permlane32_swap_b32 v7, v12
v_max_f32 v7, v7, v12
v_mul_f32 v12, s64, v7
v_sub_f32 v10, v8, v12
v_mov_b32 v8, v12
v_exp_f32 v10, v10
v_fma_f32 v64, v64, s64, -v8
v_fma_f32 v65, v65, s64, -v8
v_exp_f32 v64, v64
v_exp_f32 v65, v65
v_mul_f32 v9, v9, v10
v_cvt_pk_bf16_f32 v20, v64, v65
v_add_f32 v9, v9, v64
v_add_f32 v9, v9, v65
ds_write_b32 v219, v20 offset:0
s_branch L_vmid
L_spb:
s_mov_b32 s62, 262144
L_vchk:
s_waitcnt lgkmcnt(0)
v_readfirstlane_b32 s66, v209
s_sub_u32 s62, s62, 1
s_cmp_eq_u32 s62, 0
s_cbranch_scc1 L_vnoc
s_cmp_lg_u32 s66, 0
s_cbranch_scc1 L_vnoc
ds_read_b128 v[208:211], v217
s_branch L_vchk
L_vnoc:
v_lshl_add_u32 v219, v1, 2, s35
ds_read_b32 v20, v219 offset:0
ds_read_b32 v21, v219 offset:256
ds_read_b32 v22, v219 offset:512
ds_read_b32 v23, v219 offset:768
ds_read_b32 v24, v219 offset:1024
s_waitcnt lgkmcnt(4)
v_lshlrev_b32 v64, 16, v20
v_and_b32 v65, 0xffff0000, v20
v_max3_f32 v7, v64, v65, v7
s_waitcnt lgkmcnt(3)
v_lshlrev_b32 v66, 16, v21
v_and_b32 v67, 0xffff0000, v21
v_max3_f32 v7, v66, v67, v7
s_waitcnt lgkmcnt(2)
v_lshlrev_b32 v68, 16, v22
v_and_b32 v69, 0xffff0000, v22
v_max3_f32 v7, v68, v69, v7
s_waitcnt lgkmcnt(1)
v_lshlrev_b32 v70, 16, v23
v_and_b32 v71, 0xffff0000, v23
v_max3_f32 v7, v70, v71, v7
s_waitcnt lgkmcnt(0)
v_lshlrev_b32 v72, 16, v24
v_and_b32 v73, 0xffff0000, v24
v_max3_f32 v7, v72, v73, v7
s_nop 1
v_max_f32_dpp v7, v7, v7 quad_perm:[1,0,3,2] row_mask:0xf bank_mask:0xf
s_nop 1
v_max_f32_dpp v7, v7, v7 quad_perm:[2,3,0,1] row_mask:0xf bank_mask:0xf
s_nop 1
v_max_f32_dpp v7, v7, v7 row_half_mirror row_mask:0xf bank_mask:0xf
s_nop 1
v_max_f32_dpp v7, v7, v7 row_mirror row_mask:0xf bank_mask:0xf
v_mov_b32 v12, v7
s_nop 1
v_permlane16_swap_b32 v7, v12
v_max_f32 v7, v7, v12
v_mov_b32 v12, v7
s_nop 1
v_permlane32_swap_b32 v7, v12
v_max_f32 v7, v7, v12
v_mul_f32 v12, s64, v7
v_sub_f32 v10, v8, v12
v_mov_b32 v8, v12
v_exp_f32 v10, v10
v_fma_f32 v64, v64, s64, -v8
v_fma_f32 v65, v65, s64, -v8
v_fma_f32 v66, v66, s64, -v8
v_fma_f32 v67, v67, s64, -v8
v_fma_f32 v68, v68, s64, -v8
v_fma_f32 v69, v69, s64, -v8
v_fma_f32 v70, v70, s64, -v8
v_fma_f32 v71, v71, s64, -v8
v_fma_f32 v72, v72, s64, -v8
v_fma_f32 v73, v73, s64, -v8
v_exp_f32 v64, v64
v_exp_f32 v65, v65
v_exp_f32 v66, v66
v_exp_f32 v67, v67
v_exp_f32 v68, v68
v_exp_f32 v69, v69
v_exp_f32 v70, v70
v_exp_f32 v71, v71
v_exp_f32 v72, v72
v_exp_f32 v73, v73
v_mul_f32 v9, v9, v10
v_cvt_pk_bf16_f32 v20, v64, v65
v_add_f32 v9, v9, v64
v_add_f32 v9, v9, v65
ds_write_b32 v219, v20 offset:0
v_cvt_pk_bf16_f32 v21, v66, v67
v_add_f32 v9, v9, v66
v_add_f32 v9, v9, v67
ds_write_b32 v219, v21 offset:256
v_cvt_pk_bf16_f32 v22, v68, v69
v_add_f32 v9, v9, v68
v_add_f32 v9, v9, v69
ds_write_b32 v219, v22 offset:512
v_cvt_pk_bf16_f32 v23, v70, v71
v_add_f32 v9, v9, v70
v_add_f32 v9, v9, v71
ds_write_b32 v219, v23 offset:768
v_cvt_pk_bf16_f32 v24, v72, v73
v_add_f32 v9, v9, v72
v_add_f32 v9, v9, v73
ds_write_b32 v219, v24 offset:1024
v_mul_f32 v112, v10, v112
v_mul_f32 v116, v10, v116
v_mul_f32 v120, v10, v120
v_mul_f32 v124, v10, v124
v_mul_f32 v128, v10, v128
v_mul_f32 v132, v10, v132
v_mul_f32 v136, v10, v136
v_mul_f32 v140, v10, v140
v_mul_f32 v144, v10, v144
v_mul_f32 v148, v10, v148
v_mul_f32 v152, v10, v152
v_mul_f32 v156, v10, v156
s_nop 1
v_add_f32_dpp v9, v9, v9 quad_perm:[1,0,3,2] row_mask:0xf bank_mask:0xf
s_nop 1
v_add_f32_dpp v9, v9, v9 quad_perm:[2,3,0,1] row_mask:0xf bank_mask:0xf
s_nop 1
v_add_f32_dpp v9, v9, v9 row_half_mirror row_mask:0xf bank_mask:0xf
s_nop 1
v_add_f32_dpp v9, v9, v9 row_mirror row_mask:0xf bank_mask:0xf
v_mov_b32 v12, v9
s_nop 1
v_permlane16_swap_b32 v9, v12
v_add_f32 v9, v9, v12
v_mov_b32 v12, v9
s_nop 1
v_permlane32_swap_b32 v9, v12
v_add_f32 v9, v9, v12
s_lshl_b32 s66, s48, 10
s_add_u32 s66, s66, 132608
v_lshlrev_b32 v215, 2, v1
v_add_u32 v215, s66, v215
s_mov_b64 exec, 1
ds_write2_b32 v215, v8, v9 offset0:192 offset1:193
s_mov_b64 exec, -1
s_cmp_ge_u32 s50, 5
s_cbranch_scc1 L_vmid
v_lshrrev_b32 v12, 2, v1
v_lshlrev_b32 v12, 8, v12
v_and_b32 v13, 3, v1
v_lshl_add_u32 v12, v13, 3, v12
s_lshl_b32 s66, s48, 6
s_add_u32 s66, s66, 73728
v_add_u32 v6, s66, v12
s_add_u32 m0, s57, 1024
s_add_u32 s65, s60, 0
s_waitcnt vmcnt(6)
buffer_load_dwordx4 v221, s[28:31], s65 offen nt lds
s_waitcnt lgkmcnt(4)
ds_read_b64_tr_b16 v[160:161], v6 offset:0
ds_read_b64_tr_b16 v[162:163], v6 offset:4096
ds_read_b64_tr_b16 v[184:185], v6 offset:32
ds_read_b64_tr_b16 v[186:187], v6 offset:4128
s_add_u32 m0, s57, 2048
s_add_u32 s65, s60, 0
s_waitcnt vmcnt(6)
buffer_load_dwordx4 v222, s[28:31], s65 offen nt lds
s_waitcnt lgkmcnt(4)
ds_read_b64_tr_b16 v[164:165], v6 offset:8192
ds_read_b64_tr_b16 v[166:167], v6 offset:12288
ds_read_b64_tr_b16 v[188:189], v6 offset:8224
ds_read_b64_tr_b16 v[190:191], v6 offset:12320
s_add_u32 m0, s57, 3072
s_add_u32 s65, s60, 3072
s_waitcnt vmcnt(6)
buffer_load_dwordx4 v220, s[28:31], s65 offen nt lds
s_waitcnt lgkmcnt(4)
ds_read_b64_tr_b16 v[168:169], v6 offset:16384
ds_read_b64_tr_b16 v[170:171], v6 offset:20480
ds_read_b64_tr_b16 v[192:193], v6 offset:16416
ds_read_b64_tr_b16 v[194:195], v6 offset:20512
s_add_u32 m0, s57, 4096
s_add_u32 s65, s60, 3072
s_waitcnt vmcnt(6)
buffer_load_dwordx4 v221, s[28:31], s65 offen nt lds
s_waitcnt lgkmcnt(4)
ds_read_b64_tr_b16 v[172:173], v6 offset:24576
ds_read_b64_tr_b16 v[174:175], v6 offset:28672
ds_read_b64_tr_b16 v[196:197], v6 offset:24608
ds_read_b64_tr_b16 v[198:199], v6 offset:28704
s_add_u32 m0, s57, 5120
s_add_u32 s65, s60, 3072
s_waitcnt vmcnt(6)
buffer_load_dwordx4 v222, s[28:31], s65 offen nt lds
s_waitcnt lgkmcnt(4)
ds_read_b64_tr_b16 v[176:177], v6 offset:32768
ds_read_b64_tr_b16 v[178:179], v6 offset:36864
ds_read_b64_tr_b16 v[200:201], v6 offset:32800
ds_read_b64_tr_b16 v[202:203], v6 offset:36896
s_add_u32 m0, s57, 6144
s_add_u32 s65, s60, 6144
s_waitcnt vmcnt(6)
buffer_load_dwordx4 v220, s[28:31], s65 offen nt lds
s_waitcnt lgkmcnt(4)
ds_read_b64_tr_b16 v[180:181], v6 offset:40960
ds_read_b64_tr_b16 v[182:183], v6 offset:45056
ds_read_b64_tr_b16 v[204:205], v6 offset:40992
ds_read_b64_tr_b16 v[206:207], v6 offset:45088
s_add_u32 m0, s57, 7168
s_add_u32 s65, s60, 6144
s_waitcnt vmcnt(6)
buffer_load_dwordx4 v221, s[28:31], s65 offen nt lds
s_add_u32 m0, s57, 8192
s_add_u32 s65, s60, 6144
s_waitcnt vmcnt(6)
buffer_load_dwordx4 v222, s[28:31], s65 offen nt lds
s_waitcnt lgkmcnt(0)
s_branch L_vpe
s_branch L_vmid
L_helper:
s_getreg_b32 s68, hwreg(HW_REG_XCC_ID, 2, 1)
s_waitcnt lgkmcnt(0)
s_sub_u32 s65, s38, s36
s_min_u32 s65, s65, 400
s_sub_u32 s65, s65, 100
s_sub_u32 s66, 0, s65
s_cmp_eq_u32 s68, 0
s_cselect_b32 s65, s65, s66
v_mov_b32 v36, s65
v_mov_b32 v37, s68
v_mov_b32 v38, 0
s_lshl_b32 s65, s40, 4
s_add_u32 s65, s65, s41
s_lshl_b32 s65, s65, 4
s_add_u32 s65, s65, 4128768
v_mov_b32 v53, 137888
v_mov_b32 v12, 0
ds_write_b32 v53, v12
s_waitcnt lgkmcnt(0)
s_barrier
s_waitcnt vmcnt(0)
v_add_u32 v3, 0x9e3779b9, v3
v_mov_b32 v39, v3
s_mov_b64 exec, 1
buffer_store_dwordx4 v[36:39], v2, s[44:47], s65 offen sc1
s_mov_b64 exec, -1
s_mul_i32 s65, s3, 3
s_lshr_b32 s42, s65, 5
s_add_u32 s65, s65, 2
s_lshr_b32 s43, s65, 5
v_lshrrev_b32 v12, 5, v1
v_mul_u32_u24 v12, 12, v12
v_bfe_u32 v13, v1, 4, 1
s_sub_u32 s65, s43, s42
v_mul_u32_u24 v13, s65, v13
v_add3_u32 v12, v12, v13, s42
v_and_b32 v13, 15, v1
v_min_u32 v13, 9, v13
v_lshlrev_b32 v13, 4, v13
v_lshl_add_u32 v10, v12, 8, v13
s_andn2_b32 s66, s2, 4
s_mul_i32 s67, s66, 3
s_lshr_b32 s67, s67, 5
s_lshl_b32 s68, s67, 5
s_add_u32 s68, s68, 2
s_mul_i32 s68, s68, 43691
s_lshr_b32 s68, s68, 17
s_sub_u32 s68, s66, s68
s_lshl_b32 s67, s67, 4
s_add_u32 s67, s67, s68
s_lshl_b32 s67, s67, 4
v_mov_b32 v7, s67
s_mov_b32 s33, 4128768
s_mul_i32 s65, s49, 20480
s_lshl_b32 s66, s51, 10
s_add_u32 s65, s65, s66
s_add_u32 s28, s65, 4096
s_add_u32 s29, s28, 4096
s_add_u32 s30, s28, 8192
s_add_u32 s31, s28, 12288
s_add_u32 s32, s28, 16384
s_sub_u32 s69, s69, 5
v_mov_b32 v29, 0
v_mov_b32 v34, 0
v_mov_b32 v35, 0
v_mul_u32_u24 v6, 6, v1
v_add_u32 v6, 136704, v6
s_barrier
s_mul_i32 s65, s3, 1572864
s_load_dword s96, s[8:9], s65
s_add_u32 s65, s65, 1572860
s_load_dword s97, s[6:7], s65
s_load_dword s98, s[8:9], s65
s_sub_u32 s65, s65, 1572860
s_load_dword s99, s[6:7], s65
s_mov_b32 s65, 0x400000
s_load_dword s97, s[26:27], s65
s_mov_b32 s62, 262144
L_hwq:
ds_read_b32 v12, v53
s_sub_u32 s62, s62, 1
s_cmp_eq_u32 s62, 0
s_cbranch_scc1 L_hwq_ok
s_waitcnt lgkmcnt(0)
v_readfirstlane_b32 s65, v12
s_nop 0
s_cmp_ge_u32 s65, 4
s_cbranch_scc1 L_hwq_ok

s_branch L_hwq
L_hwq_ok:
s_mov_b32 s62, 32768
L_pq:
buffer_load_dwordx4 v[64:67], v2, s[44:47], s28 offen sc1
buffer_load_dwordx4 v[68:71], v2, s[44:47], s29 offen sc1
buffer_load_dwordx4 v[72:75], v2, s[44:47], s30 offen sc1
buffer_load_dwordx4 v[76:79], v2, s[44:47], s31 offen sc1
buffer_load_dwordx4 v[80:83], v2, s[44:47], s32 offen sc1
buffer_load_dwordx4 v[84:87], v10, s[44:47], s33 offen sc1
buffer_load_dwordx4 v[88:91], v7, s[44:47], s33 offen sc1
s_waitcnt vmcnt(0)
v_xor_b32 v12, v67, v3
v_xor_b32 v13, v71, v3
v_or_b32 v12, v12, v13
v_xor_b32 v13, v75, v3
v_or_b32 v12, v12, v13
v_xor_b32 v13, v79, v3
v_or_b32 v12, v12, v13
v_xor_b32 v13, v83, v3
v_or_b32 v12, v12, v13
v_xor_b32 v13, v87, v3
v_or_b32 v12, v12, v13
v_xor_b32 v13, v91, v3
v_or_b32 v12, v12, v13
v_cmp_ne_u32 vcc, 0, v12
s_cbranch_vccz L_pq_ok
s_sub_u32 s62, s62, 1
s_cmp_lg_u32 s62, 0
s_cbranch_scc1 L_pq
v_mov_b32 v12, 0
v_mov_b32 v13, 1
global_store_dword v12, v13, s[24:25]
L_pq_ok:
v_add_f32 v160, v64, v68
v_add_f32 v161, v65, v69
v_add_f32 v162, v66, v70
v_add_f32 v160, v160, v72
v_add_f32 v161, v161, v73
v_add_f32 v162, v162, v74
v_add_f32 v160, v160, v76
v_add_f32 v161, v161, v77
v_add_f32 v162, v162, v78
v_add_f32 v160, v160, v80
v_add_f32 v161, v161, v81
v_add_f32 v162, v162, v82
v_cvt_pk_bf16_f32 v12, v160, v161
v_cvt_pk_bf16_f32 v13, v162, v162
ds_write_b16 v6, v12
ds_write_b16_d16_hi v6, v12 offset:2
ds_write_b16 v6, v13 offset:4
v_and_b32 v12, 15, v1
v_cmp_gt_u32 vcc, 10, v12
v_readfirstlane_b32 s67, v89
s_nop 0
v_cndmask_b32 v163, 0, v84, vcc
s_nop 1
v_add_u32_dpp v163, v163, v163 quad_perm:[1,0,3,2] row_mask:0xf bank_mask:0xf
s_nop 1
v_add_u32_dpp v163, v163, v163 quad_perm:[2,3,0,1] row_mask:0xf bank_mask:0xf
s_nop 1
v_add_u32_dpp v163, v163, v163 row_half_mirror row_mask:0xf bank_mask:0xf
s_nop 1
v_add_u32_dpp v163, v163, v163 row_mirror row_mask:0xf bank_mask:0xf
v_lshrrev_b32 v163, 31, v163
v_xor_b32 v163, s67, v163
s_nop 0
v_readlane_b32 s36, v163, 0
v_readlane_b32 s37, v163, 16
v_readlane_b32 s38, v163, 32
v_readlane_b32 s39, v163, 48
s_lshr_b32 s97, s3, 2
s_mul_i32 s68, s97, 43691
s_lshr_b32 s68, s68, 17
s_mul_i32 s68, s68, 3
s_sub_u32 s97, s97, s68
s_mov_b32 s65, 0
s_mov_b32 s66, 0
s_mul_i32 s68, s3, 3
s_add_u32 s68, s68, s97
s_lshl_b32 s68, s68, 19
s_lshr_b32 s67, s68, 24
s_cmp_eq_u32 s67, s42
s_cselect_b32 s92, s36, s37
s_cselect_b32 s93, s38, s39
s_add_u32 s67, s6, s68
s_lshr_b32 s67, s67, 21
s_xor_b32 s67, s67, s92
s_and_b32 s67, s67, 1
s_lshl_b32 s67, s67, 0
s_or_b32 s65, s65, s67
s_add_u32 s67, s8, s68
s_lshr_b32 s67, s67, 21
s_xor_b32 s67, s67, s93
s_and_b32 s67, s67, 1
s_lshl_b32 s67, s67, 0
s_or_b32 s66, s66, s67
s_add_u32 s97, s97, 1
s_cmp_eq_u32 s97, 3
s_cselect_b32 s97, 0, s97
s_mul_i32 s68, s3, 3
s_add_u32 s68, s68, s97
s_lshl_b32 s68, s68, 19
s_lshr_b32 s67, s68, 24
s_cmp_eq_u32 s67, s42
s_cselect_b32 s92, s36, s37
s_cselect_b32 s93, s38, s39
s_add_u32 s67, s6, s68
s_lshr_b32 s67, s67, 21
s_xor_b32 s67, s67, s92
s_and_b32 s67, s67, 1
s_lshl_b32 s67, s67, 1
s_or_b32 s65, s65, s67
s_add_u32 s67, s8, s68
s_lshr_b32 s67, s67, 21
s_xor_b32 s67, s67, s93
s_and_b32 s67, s67, 1
s_lshl_b32 s67, s67, 1
s_or_b32 s66, s66, s67
s_add_u32 s97, s97, 1
s_cmp_eq_u32 s97, 3
s_cselect_b32 s97, 0, s97
s_mul_i32 s68, s3, 3
s_add_u32 s68, s68, s97
s_lshl_b32 s68, s68, 19
s_lshr_b32 s67, s68, 24
s_cmp_eq_u32 s67, s42
s_cselect_b32 s92, s36, s37
s_cselect_b32 s93, s38, s39
s_add_u32 s67, s6, s68
s_lshr_b32 s67, s67, 21
s_xor_b32 s67, s67, s92
s_and_b32 s67, s67, 1
s_lshl_b32 s67, s67, 2
s_or_b32 s65, s65, s67
s_add_u32 s67, s8, s68
s_lshr_b32 s67, s67, 21
s_xor_b32 s67, s67, s93
s_and_b32 s67, s67, 1
s_lshl_b32 s67, s67, 2
s_or_b32 s66, s66, s67
s_xor_b32 s92, s65, s66
s_cselect_b32 s93, 0, 1
v_mov_b32 v16, s65
v_mov_b32 v17, s66
v_mov_b32 v15, 137856
ds_write_b64 v15, v[16:17]
v_mov_b32 v20, 0
v_mov_b32 v21, s93
v_mov_b32 v22, 0
v_mov_b32 v23, 0
ds_write_b128 v15, v[20:23] offset:16
s_waitcnt lgkmcnt(0)
s_barrier
s_waitcnt vmcnt(0)
s_cmp_ge_u32 s50, 5
s_cselect_b32 s55, 1, 0
s_cmp_lt_u32 s69, 80
s_cselect_b32 s55, s55, 0
s_cmp_eq_u32 s55, 0
s_cbranch_scc1 L_hx
s_mul_i32 s70, s69, 52429
s_lshr_b32 s70, s70, 18
s_mul_i32 s65, s70, 5
s_sub_u32 s71, s69, s65
s_mul_i32 s72, s69, 52429
s_lshr_b32 s72, s72, 20
s_mul_i32 s65, s72, 20
s_sub_u32 s73, s69, s65
v_lshrrev_b32 v12, 4, v1
v_and_b32 v13, 15, v1
v_lshlrev_b32 v13, 4, v13
v_mul_u32_u24 v28, 1280, v12
v_add_u32 v28, v28, v13
v_lshl_add_u32 v29, v12, 10, v13
v_lshrrev_b32 v12, 5, v1
v_mul_u32_u24 v12, 163840, v12
v_and_b32 v13, 31, v1
v_lshl_add_u32 v6, v13, 4, v12
s_lshr_b32 s65, s70, 1
s_add_u32 s65, s65, 32
s_mul_i32 s65, s65, 20480
s_and_b32 s66, s70, 1
s_lshl_b32 s66, s66, 9
s_add_u32 s65, s65, s66
s_add_u32 s28, s65, 4096
s_add_u32 s29, s28, 4096
s_add_u32 s30, s28, 8192
s_add_u32 s31, s28, 12288
s_add_u32 s32, s28, 16384
s_mov_b32 s62, 32768
L_pg:
buffer_load_dwordx4 v[64:67], v6, s[44:47], s28 offen offset:0 sc1
buffer_load_dwordx4 v[68:71], v6, s[44:47], s29 offen offset:0 sc1
buffer_load_dwordx4 v[72:75], v6, s[44:47], s30 offen offset:0 sc1
buffer_load_dwordx4 v[76:79], v6, s[44:47], s31 offen offset:0 sc1
buffer_load_dwordx4 v[80:83], v6, s[44:47], s32 offen offset:0 sc1
buffer_load_dwordx4 v[84:87], v6, s[44:47], s28 offen offset:1024 sc1
buffer_load_dwordx4 v[88:91], v6, s[44:47], s29 offen offset:1024 sc1
buffer_load_dwordx4 v[92:95], v6, s[44:47], s30 offen offset:1024 sc1
buffer_load_dwordx4 v[96:99], v6, s[44:47], s31 offen offset:1024 sc1
buffer_load_dwordx4 v[100:103], v6, s[44:47], s32 offen offset:1024 sc1
buffer_load_dwordx4 v[104:107], v6, s[44:47], s28 offen offset:2048 sc1
buffer_load_dwordx4 v[108:111], v6, s[44:47], s29 offen offset:2048 sc1
buffer_load_dwordx4 v[112:115], v6, s[44:47], s30 offen offset:2048 sc1
buffer_load_dwordx4 v[116:119], v6, s[44:47], s31 offen offset:2048 sc1
buffer_load_dwordx4 v[120:123], v6, s[44:47], s32 offen offset:2048 sc1
buffer_load_dwordx4 v[124:127], v6, s[44:47], s28 offen offset:3072 sc1
buffer_load_dwordx4 v[128:131], v6, s[44:47], s29 offen offset:3072 sc1
buffer_load_dwordx4 v[132:135], v6, s[44:47], s30 offen offset:3072 sc1
buffer_load_dwordx4 v[136:139], v6, s[44:47], s31 offen offset:3072 sc1
buffer_load_dwordx4 v[140:143], v6, s[44:47], s32 offen offset:3072 sc1
s_waitcnt vmcnt(0)
v_xor_b32 v12, v67, v3
v_xor_b32 v13, v71, v3
v_or_b32 v12, v12, v13
v_xor_b32 v13, v75, v3
v_or_b32 v12, v12, v13
v_xor_b32 v13, v79, v3
v_or_b32 v12, v12, v13
v_xor_b32 v13, v83, v3
v_or_b32 v12, v12, v13
v_xor_b32 v13, v87, v3
v_or_b32 v12, v12, v13
v_xor_b32 v13, v91, v3
v_or_b32 v12, v12, v13
v_xor_b32 v13, v95, v3
v_or_b32 v12, v12, v13
v_xor_b32 v13, v99, v3
v_or_b32 v12, v12, v13
v_xor_b32 v13, v103, v3
v_or_b32 v12, v12, v13
v_xor_b32 v13, v107, v3
v_or_b32 v12, v12, v13
v_xor_b32 v13, v111, v3
v_or_b32 v12, v12, v13
v_xor_b32 v13, v115, v3
v_or_b32 v12, v12, v13
v_xor_b32 v13, v119, v3
v_or_b32 v12, v12, v13
v_xor_b32 v13, v123, v3
v_or_b32 v12, v12, v13
v_xor_b32 v13, v127, v3
v_or_b32 v12, v12, v13
v_xor_b32 v13, v131, v3
v_or_b32 v12, v12, v13
v_xor_b32 v13, v135, v3
v_or_b32 v12, v12, v13
v_xor_b32 v13, v139, v3
v_or_b32 v12, v12, v13
v_xor_b32 v13, v143, v3
v_or_b32 v12, v12, v13
v_cmp_ne_u32 vcc, 0, v12
s_cbranch_vccz L_pg_ok
s_sub_u32 s62, s62, 1
s_cmp_lg_u32 s62, 0
s_cbranch_scc1 L_pg
v_mov_b32 v12, 0
v_mov_b32 v13, 2
global_store_dword v12, v13, s[24:25]
L_pg_ok:
v_and_b32 v6, 31, v1
v_mul_u32_u24 v6, 6, v6
v_add_u32 v6, 137088, v6
v_add_f32 v64, v64, v68
v_add_f32 v64, v64, v72
v_add_f32 v64, v64, v76
v_add_f32 v64, v64, v80
v_add_f32 v65, v65, v69
v_add_f32 v65, v65, v73
v_add_f32 v65, v65, v77
v_add_f32 v65, v65, v81
v_add_f32 v66, v66, v70
v_add_f32 v66, v66, v74
v_add_f32 v66, v66, v78
v_add_f32 v66, v66, v82
v_cvt_pk_bf16_f32 v12, v64, v65
v_lshlrev_b32 v64, 16, v12
v_and_b32 v65, 0xffff0000, v12
v_cvt_pk_bf16_f32 v12, v66, v66
v_lshlrev_b32 v66, 16, v12
v_mov_b32 v68, v64
v_mov_b32 v69, v65
v_mov_b32 v70, v66
s_nop 1
v_permlane32_swap_b32 v64, v68
v_permlane32_swap_b32 v65, v69
v_permlane32_swap_b32 v66, v70
v_cmp_lt_f32 vcc, 0, v64
s_nop 1
v_cndmask_b32 v12, 0, 1.0, vcc
v_mul_f32 v64, v64, v12
v_mul_f32 v64, v64, v68
v_cmp_lt_f32 vcc, 0, v65
s_nop 1
v_cndmask_b32 v12, 0, 1.0, vcc
v_mul_f32 v65, v65, v12
v_mul_f32 v65, v65, v69
v_cmp_lt_f32 vcc, 0, v66
s_nop 1
v_cndmask_b32 v12, 0, 1.0, vcc
v_mul_f32 v66, v66, v12
v_mul_f32 v66, v66, v70
v_cvt_pk_bf16_f32 v12, v64, v65
v_cvt_pk_bf16_f32 v13, v66, v66
ds_write_b16 v6, v12
ds_write_b16_d16_hi v6, v12 offset:2
ds_write_b16 v6, v13 offset:4
v_add_u32 v6, 192, v6
v_add_f32 v84, v84, v88
v_add_f32 v84, v84, v92
v_add_f32 v84, v84, v96
v_add_f32 v84, v84, v100
v_add_f32 v85, v85, v89
v_add_f32 v85, v85, v93
v_add_f32 v85, v85, v97
v_add_f32 v85, v85, v101
v_add_f32 v86, v86, v90
v_add_f32 v86, v86, v94
v_add_f32 v86, v86, v98
v_add_f32 v86, v86, v102
v_cvt_pk_bf16_f32 v12, v84, v85
v_lshlrev_b32 v84, 16, v12
v_and_b32 v85, 0xffff0000, v12
v_cvt_pk_bf16_f32 v12, v86, v86
v_lshlrev_b32 v86, 16, v12
v_mov_b32 v88, v84
v_mov_b32 v89, v85
v_mov_b32 v90, v86
s_nop 1
v_permlane32_swap_b32 v84, v88
v_permlane32_swap_b32 v85, v89
v_permlane32_swap_b32 v86, v90
v_cmp_lt_f32 vcc, 0, v84
s_nop 1
v_cndmask_b32 v12, 0, 1.0, vcc
v_mul_f32 v84, v84, v12
v_mul_f32 v84, v84, v88
v_cmp_lt_f32 vcc, 0, v85
s_nop 1
v_cndmask_b32 v12, 0, 1.0, vcc
v_mul_f32 v85, v85, v12
v_mul_f32 v85, v85, v89
v_cmp_lt_f32 vcc, 0, v86
s_nop 1
v_cndmask_b32 v12, 0, 1.0, vcc
v_mul_f32 v86, v86, v12
v_mul_f32 v86, v86, v90
v_cvt_pk_bf16_f32 v12, v84, v85
v_cvt_pk_bf16_f32 v13, v86, v86
ds_write_b16 v6, v12
ds_write_b16_d16_hi v6, v12 offset:2
ds_write_b16 v6, v13 offset:4
v_add_u32 v6, 192, v6
v_add_f32 v104, v104, v108
v_add_f32 v104, v104, v112
v_add_f32 v104, v104, v116
v_add_f32 v104, v104, v120
v_add_f32 v105, v105, v109
v_add_f32 v105, v105, v113
v_add_f32 v105, v105, v117
v_add_f32 v105, v105, v121
v_add_f32 v106, v106, v110
v_add_f32 v106, v106, v114
v_add_f32 v106, v106, v118
v_add_f32 v106, v106, v122
v_cvt_pk_bf16_f32 v12, v104, v105
v_lshlrev_b32 v104, 16, v12
v_and_b32 v105, 0xffff0000, v12
v_cvt_pk_bf16_f32 v12, v106, v106
v_lshlrev_b32 v106, 16, v12
v_mov_b32 v108, v104
v_mov_b32 v109, v105
v_mov_b32 v110, v106
s_nop 1
v_permlane32_swap_b32 v104, v108
v_permlane32_swap_b32 v105, v109
v_permlane32_swap_b32 v106, v110
v_cmp_lt_f32 vcc, 0, v104
s_nop 1
v_cndmask_b32 v12, 0, 1.0, vcc
v_mul_f32 v104, v104, v12
v_mul_f32 v104, v104, v108
v_cmp_lt_f32 vcc, 0, v105
s_nop 1
v_cndmask_b32 v12, 0, 1.0, vcc
v_mul_f32 v105, v105, v12
v_mul_f32 v105, v105, v109
v_cmp_lt_f32 vcc, 0, v106
s_nop 1
v_cndmask_b32 v12, 0, 1.0, vcc
v_mul_f32 v106, v106, v12
v_mul_f32 v106, v106, v110
v_cvt_pk_bf16_f32 v12, v104, v105
v_cvt_pk_bf16_f32 v13, v106, v106
ds_write_b16 v6, v12
ds_write_b16_d16_hi v6, v12 offset:2
ds_write_b16 v6, v13 offset:4
v_add_u32 v6, 192, v6
v_add_f32 v124, v124, v128
v_add_f32 v124, v124, v132
v_add_f32 v124, v124, v136
v_add_f32 v124, v124, v140
v_add_f32 v125, v125, v129
v_add_f32 v125, v125, v133
v_add_f32 v125, v125, v137
v_add_f32 v125, v125, v141
v_add_f32 v126, v126, v130
v_add_f32 v126, v126, v134
v_add_f32 v126, v126, v138
v_add_f32 v126, v126, v142
v_cvt_pk_bf16_f32 v12, v124, v125
v_lshlrev_b32 v124, 16, v12
v_and_b32 v125, 0xffff0000, v12
v_cvt_pk_bf16_f32 v12, v126, v126
v_lshlrev_b32 v126, 16, v12
v_mov_b32 v128, v124
v_mov_b32 v129, v125
v_mov_b32 v130, v126
s_nop 1
v_permlane32_swap_b32 v124, v128
v_permlane32_swap_b32 v125, v129
v_permlane32_swap_b32 v126, v130
v_cmp_lt_f32 vcc, 0, v124
s_nop 1
v_cndmask_b32 v12, 0, 1.0, vcc
v_mul_f32 v124, v124, v12
v_mul_f32 v124, v124, v128
v_cmp_lt_f32 vcc, 0, v125
s_nop 1
v_cndmask_b32 v12, 0, 1.0, vcc
v_mul_f32 v125, v125, v12
v_mul_f32 v125, v125, v129
v_cmp_lt_f32 vcc, 0, v126
s_nop 1
v_cndmask_b32 v12, 0, 1.0, vcc
v_mul_f32 v126, v126, v12
v_mul_f32 v126, v126, v130
v_cvt_pk_bf16_f32 v12, v124, v125
v_cvt_pk_bf16_f32 v13, v126, v126
ds_write_b16 v6, v12
ds_write_b16_d16_hi v6, v12 offset:2
ds_write_b16 v6, v13 offset:4
v_bfe_u32 v14, v1, 2, 2
v_mul_u32_u24 v14, 192, v14
v_lshrrev_b32 v15, 4, v1
v_lshl_add_u32 v14, v15, 3, v14
v_add_u32 v6, 137088, v14
s_waitcnt lgkmcnt(0)
ds_read2_b64 v[40:43], v6 offset0:0 offset1:4
ds_read2_b64 v[44:47], v6 offset0:8 offset1:12
ds_read2_b64 v[48:51], v6 offset0:16 offset1:20
v_lshrrev_b32 v12, 2, v1
v_lshlrev_b32 v12, 8, v12
v_and_b32 v13, 3, v1
v_lshl_add_u32 v12, v13, 3, v12
v_add_u32 v6, 73728, v12
s_waitcnt lgkmcnt(0)
ds_read_b64_tr_b16 v[64:65], v6 offset:0
ds_read_b64_tr_b16 v[66:67], v6 offset:4096
ds_read_b64_tr_b16 v[68:69], v6 offset:32
ds_read_b64_tr_b16 v[70:71], v6 offset:4128
ds_read_b64_tr_b16 v[72:73], v6 offset:64
ds_read_b64_tr_b16 v[74:75], v6 offset:4160
ds_read_b64_tr_b16 v[76:77], v6 offset:96
ds_read_b64_tr_b16 v[78:79], v6 offset:4192
ds_read_b64_tr_b16 v[80:81], v6 offset:128
ds_read_b64_tr_b16 v[82:83], v6 offset:4224
s_waitcnt lgkmcnt(8)
v_mfma_f32_16x16x32_bf16 v[112:115], v[40:43], v[64:67], 0
ds_read_b64_tr_b16 v[84:85], v6 offset:160
ds_read_b64_tr_b16 v[86:87], v6 offset:4256
s_waitcnt lgkmcnt(8)
v_mfma_f32_16x16x32_bf16 v[116:119], v[40:43], v[68:71], 0
ds_read_b64_tr_b16 v[88:89], v6 offset:192
ds_read_b64_tr_b16 v[90:91], v6 offset:4288
s_waitcnt lgkmcnt(8)
v_mfma_f32_16x16x32_bf16 v[120:123], v[40:43], v[72:75], 0
ds_read_b64_tr_b16 v[92:93], v6 offset:224
ds_read_b64_tr_b16 v[94:95], v6 offset:4320
s_waitcnt lgkmcnt(8)
v_mfma_f32_16x16x32_bf16 v[124:127], v[40:43], v[76:79], 0
s_waitcnt lgkmcnt(6)
v_mfma_f32_16x16x32_bf16 v[128:131], v[40:43], v[80:83], 0
s_waitcnt lgkmcnt(4)
v_mfma_f32_16x16x32_bf16 v[132:135], v[40:43], v[84:87], 0
s_waitcnt lgkmcnt(2)
v_mfma_f32_16x16x32_bf16 v[136:139], v[40:43], v[88:91], 0
s_waitcnt lgkmcnt(0)
v_mfma_f32_16x16x32_bf16 v[140:143], v[40:43], v[92:95], 0
v_add_u32 v6, 8192, v6
s_waitcnt lgkmcnt(0)
ds_read_b64_tr_b16 v[64:65], v6 offset:0
ds_read_b64_tr_b16 v[66:67], v6 offset:4096
ds_read_b64_tr_b16 v[68:69], v6 offset:32
ds_read_b64_tr_b16 v[70:71], v6 offset:4128
ds_read_b64_tr_b16 v[72:73], v6 offset:64
ds_read_b64_tr_b16 v[74:75], v6 offset:4160
ds_read_b64_tr_b16 v[76:77], v6 offset:96
ds_read_b64_tr_b16 v[78:79], v6 offset:4192
ds_read_b64_tr_b16 v[80:81], v6 offset:128
ds_read_b64_tr_b16 v[82:83], v6 offset:4224
s_waitcnt lgkmcnt(8)
v_mfma_f32_16x16x32_bf16 v[112:115], v[44:47], v[64:67], v[112:115]
ds_read_b64_tr_b16 v[84:85], v6 offset:160
ds_read_b64_tr_b16 v[86:87], v6 offset:4256
s_waitcnt lgkmcnt(8)
v_mfma_f32_16x16x32_bf16 v[116:119], v[44:47], v[68:71], v[116:119]
ds_read_b64_tr_b16 v[88:89], v6 offset:192
ds_read_b64_tr_b16 v[90:91], v6 offset:4288
s_waitcnt lgkmcnt(8)
v_mfma_f32_16x16x32_bf16 v[120:123], v[44:47], v[72:75], v[120:123]
ds_read_b64_tr_b16 v[92:93], v6 offset:224
ds_read_b64_tr_b16 v[94:95], v6 offset:4320
s_waitcnt lgkmcnt(8)
v_mfma_f32_16x16x32_bf16 v[124:127], v[44:47], v[76:79], v[124:127]
s_waitcnt lgkmcnt(6)
v_mfma_f32_16x16x32_bf16 v[128:131], v[44:47], v[80:83], v[128:131]
s_waitcnt lgkmcnt(4)
v_mfma_f32_16x16x32_bf16 v[132:135], v[44:47], v[84:87], v[132:135]
s_waitcnt lgkmcnt(2)
v_mfma_f32_16x16x32_bf16 v[136:139], v[44:47], v[88:91], v[136:139]
s_waitcnt lgkmcnt(0)
v_mfma_f32_16x16x32_bf16 v[140:143], v[44:47], v[92:95], v[140:143]
v_add_u32 v6, 8192, v6
s_waitcnt lgkmcnt(0)
ds_read_b64_tr_b16 v[64:65], v6 offset:0
ds_read_b64_tr_b16 v[66:67], v6 offset:4096
ds_read_b64_tr_b16 v[68:69], v6 offset:32
ds_read_b64_tr_b16 v[70:71], v6 offset:4128
ds_read_b64_tr_b16 v[72:73], v6 offset:64
ds_read_b64_tr_b16 v[74:75], v6 offset:4160
ds_read_b64_tr_b16 v[76:77], v6 offset:96
ds_read_b64_tr_b16 v[78:79], v6 offset:4192
ds_read_b64_tr_b16 v[80:81], v6 offset:128
ds_read_b64_tr_b16 v[82:83], v6 offset:4224
s_waitcnt lgkmcnt(8)
v_mfma_f32_16x16x32_bf16 v[112:115], v[48:51], v[64:67], v[112:115]
ds_read_b64_tr_b16 v[84:85], v6 offset:160
ds_read_b64_tr_b16 v[86:87], v6 offset:4256
s_waitcnt lgkmcnt(8)
v_mfma_f32_16x16x32_bf16 v[116:119], v[48:51], v[68:71], v[116:119]
ds_read_b64_tr_b16 v[88:89], v6 offset:192
ds_read_b64_tr_b16 v[90:91], v6 offset:4288
s_waitcnt lgkmcnt(8)
v_mfma_f32_16x16x32_bf16 v[120:123], v[48:51], v[72:75], v[120:123]
ds_read_b64_tr_b16 v[92:93], v6 offset:224
ds_read_b64_tr_b16 v[94:95], v6 offset:4320
s_waitcnt lgkmcnt(8)
v_mfma_f32_16x16x32_bf16 v[124:127], v[48:51], v[76:79], v[124:127]
s_waitcnt lgkmcnt(6)
v_mfma_f32_16x16x32_bf16 v[128:131], v[48:51], v[80:83], v[128:131]
s_waitcnt lgkmcnt(4)
v_mfma_f32_16x16x32_bf16 v[132:135], v[48:51], v[84:87], v[132:135]
s_waitcnt lgkmcnt(2)
v_mfma_f32_16x16x32_bf16 v[136:139], v[48:51], v[88:91], v[136:139]
s_waitcnt lgkmcnt(0)
v_mfma_f32_16x16x32_bf16 v[140:143], v[48:51], v[92:95], v[140:143]
s_lshl_b32 s39, s71, 6
s_add_u32 s39, s39, s70
s_lshl_b32 s39, s39, 10
s_add_u32 s39, s39, 3145728
s_nop 4
v_mov_b32 v176, v112
v_mov_b32 v177, v116
v_mov_b32 v178, v3
v_mov_b32 v179, v3
v_mov_b32 v180, v120
v_mov_b32 v181, v124
v_mov_b32 v182, v3
v_mov_b32 v183, v3
v_mov_b32 v184, v128
v_mov_b32 v185, v132
v_mov_b32 v186, v3
v_mov_b32 v187, v3
v_mov_b32 v188, v136
v_mov_b32 v189, v140
v_mov_b32 v190, v3
v_mov_b32 v191, v3
s_mul_i32 s65, s72, 1280
s_lshl_b32 s66, s73, 6
s_add_u32 s65, s65, s66
v_and_b32 v34, 15, v1
v_lshlrev_b32 v34, 1, v34
v_add_u32 v34, s65, v34
global_load_ushort v32, v34, s[4:5]
global_load_ushort v33, v34, s[4:5] offset:32
s_lshl_b32 s65, s73, 14
s_lshl_b32 s66, s72, 8
s_add_u32 s65, s65, s66
s_add_u32 s40, s65, 3145728
s_add_u32 s41, s40, 4096
s_add_u32 s42, s40, 8192
s_add_u32 s43, s40, 12288
s_waitcnt vmcnt(0)
v_lshlrev_b32 v32, 16, v32
v_lshlrev_b32 v33, 16, v33
s_lshl_b32 s65, s73, 15
s_lshl_b32 s66, s72, 8
s_add_u32 s65, s65, s66
s_add_u32 s28, s65, 2097152
s_add_u32 s29, s28, 4096
s_add_u32 s30, s28, 8192
s_add_u32 s31, s28, 12288
s_add_u32 s32, s28, 16384
s_add_u32 s33, s28, 20480
s_add_u32 s34, s28, 24576
s_add_u32 s35, s28, 28672
v_lshrrev_b32 v35, 1, v29
s_branch L_hx
.p2align 12
L_hx:
s_lshl_b32 s36, s3, 1
s_add_u32 s37, s36, 1
s_sub_u32 s37, s37, s52
s_add_u32 s36, s36, s52
s_mul_i32 s36, s36, 6144
s_add_u32 s36, s36, 4194304
s_mul_i32 s37, s37, 6144
s_add_u32 s37, s37, 4194304
v_mov_b32 v55, v2
v_add_u32 v52, 137920, v2
v_mov_b32 v53, 137872
v_and_b32 v12, 3, v1
v_cmp_eq_u32 vcc, 2, v12
v_mov_b32 v12, -20
s_nop 0
v_cndmask_b32 v12, 8, v12, vcc
v_add_u32 v54, v52, v12
s_bitcmp1_b32 s92, 0
s_cselect_b32 s96, 0xffffff00, 0
s_bitcmp1_b32 s92, 1
s_cselect_b32 s97, -1, 0
s_bitcmp1_b32 s92, 2
s_cselect_b32 s98, 0xffffff, 0
s_mov_b32 s99, 0
s_mov_b32 s62, 262144
L_hw0:
ds_read_b32 v12, v53
s_sub_u32 s62, s62, 1
s_cmp_eq_u32 s62, 0
s_cbranch_scc1 L_hw0_ok
s_waitcnt lgkmcnt(0)
v_readfirstlane_b32 s65, v12
s_nop 0
s_cmp_ge_u32 s65, 92
s_cbranch_scc1 L_hw0_ok

s_branch L_hw0
L_hw0_ok:
s_memrealtime s[74:75]
s_lshl_b32 s66, s2, 4
s_add_u32 s66, s66, 4063232
v_mov_b32 v39, v3
s_waitcnt lgkmcnt(0)
s_add_u32 s38, s74, 0
v_mov_b32 v36, s38
s_mov_b64 exec, 1
buffer_store_dwordx4 v[36:39], v2, s[44:47], s66 offen sc1
s_mov_b64 exec, -1
s_cmp_eq_u64 s[96:97], 0
s_cbranch_scc1 L_np0
s_mov_b64 exec, s[96:97]
ds_read_b64 v[64:65], v52 offset:0
ds_read_b32 v66, v54 offset:0
v_mov_b32 v67, v3
ds_read_b64 v[68:69], v52 offset:1536
ds_read_b32 v70, v54 offset:1536
v_mov_b32 v71, v3
ds_read_b64 v[72:73], v52 offset:3072
ds_read_b32 v74, v54 offset:3072
v_mov_b32 v75, v3
ds_read_b64 v[76:77], v52 offset:4608
ds_read_b32 v78, v54 offset:4608
v_mov_b32 v79, v3
s_add_u32 s65, s36, 0
s_waitcnt lgkmcnt(6)
buffer_store_dwordx4 v[64:67], v55, s[44:47], s65 offen sc1
s_add_u32 s65, s36, 1536
s_waitcnt lgkmcnt(4)
buffer_store_dwordx4 v[68:71], v55, s[44:47], s65 offen sc1
s_add_u32 s65, s36, 3072
s_waitcnt lgkmcnt(2)
buffer_store_dwordx4 v[72:75], v55, s[44:47], s65 offen sc1
s_add_u32 s65, s36, 4608
s_waitcnt lgkmcnt(0)
buffer_store_dwordx4 v[76:79], v55, s[44:47], s65 offen sc1
s_mov_b64 exec, -1
L_np0:
s_cmp_eq_u64 s[98:99], 0
s_cbranch_scc1 L_np1
s_mov_b64 exec, s[98:99]
ds_read_b64 v[80:81], v52 offset:1024
ds_read_b32 v82, v54 offset:1024
v_mov_b32 v83, v3
ds_read_b64 v[84:85], v52 offset:2560
ds_read_b32 v86, v54 offset:2560
v_mov_b32 v87, v3
ds_read_b64 v[88:89], v52 offset:4096
ds_read_b32 v90, v54 offset:4096
v_mov_b32 v91, v3
ds_read_b64 v[92:93], v52 offset:5632
ds_read_b32 v94, v54 offset:5632
v_mov_b32 v95, v3
s_add_u32 s65, s36, 1024
s_waitcnt lgkmcnt(6)
buffer_store_dwordx4 v[80:83], v55, s[44:47], s65 offen sc1
s_add_u32 s65, s36, 2560
s_waitcnt lgkmcnt(4)
buffer_store_dwordx4 v[84:87], v55, s[44:47], s65 offen sc1
s_add_u32 s65, s36, 4096
s_waitcnt lgkmcnt(2)
buffer_store_dwordx4 v[88:91], v55, s[44:47], s65 offen sc1
s_add_u32 s65, s36, 5632
s_waitcnt lgkmcnt(0)
buffer_store_dwordx4 v[92:95], v55, s[44:47], s65 offen sc1
s_mov_b64 exec, -1
L_np1:
s_mov_b32 s62, 262144
L_hw1:
ds_read_b32 v12, v53
s_sub_u32 s62, s62, 1
s_cmp_eq_u32 s62, 0
s_cbranch_scc1 L_hw1_ok
s_waitcnt lgkmcnt(0)
v_readfirstlane_b32 s65, v12
s_nop 0
s_cmp_ge_u32 s65, 104
s_cbranch_scc1 L_hw1_ok

s_branch L_hw1
L_hw1_ok:
v_lshlrev_b32 v14, 6, v1
v_bfe_u32 v15, v1, 1, 2
v_lshl_add_u32 v14, v15, 4, v14
s_mov_b32 s66, 4063232
buffer_load_dwordx4 v[192:195], v14, s[44:47], s66 offen sc1
s_memrealtime s[74:75]
s_cmp_lg_u32 s93, 0
s_cbranch_scc1 L_nox
v_mov_b32 v115, v3
v_mov_b32 v119, v3
v_mov_b32 v123, v3
v_mov_b32 v127, v3
v_mov_b32 v131, v3
v_mov_b32 v135, v3
v_mov_b32 v139, v3
v_mov_b32 v143, v3
s_mov_b32 s62, 32768
L_px:
s_cmp_eq_u64 s[96:97], 0
s_cbranch_scc1 L_ng0
s_mov_b64 exec, s[96:97]
s_add_u32 s65, s37, 0
buffer_load_dwordx4 v[112:115], v55, s[44:47], s65 offen sc1
s_add_u32 s65, s37, 1536
buffer_load_dwordx4 v[116:119], v55, s[44:47], s65 offen sc1
s_add_u32 s65, s37, 3072
buffer_load_dwordx4 v[120:123], v55, s[44:47], s65 offen sc1
s_add_u32 s65, s37, 4608
buffer_load_dwordx4 v[124:127], v55, s[44:47], s65 offen sc1
s_mov_b64 exec, -1
L_ng0:
s_cmp_eq_u64 s[98:99], 0
s_cbranch_scc1 L_ng1
s_mov_b64 exec, s[98:99]
s_add_u32 s65, s37, 1024
buffer_load_dwordx4 v[128:131], v55, s[44:47], s65 offen sc1
s_add_u32 s65, s37, 2560
buffer_load_dwordx4 v[132:135], v55, s[44:47], s65 offen sc1
s_add_u32 s65, s37, 4096
buffer_load_dwordx4 v[136:139], v55, s[44:47], s65 offen sc1
s_add_u32 s65, s37, 5632
buffer_load_dwordx4 v[140:143], v55, s[44:47], s65 offen sc1
s_mov_b64 exec, -1
L_ng1:
s_waitcnt vmcnt(0)
v_xor_b32 v12, v115, v3
v_xor_b32 v13, v119, v3
v_or_b32 v12, v12, v13
v_xor_b32 v13, v123, v3
v_or_b32 v12, v12, v13
v_xor_b32 v13, v127, v3
v_or_b32 v12, v12, v13
v_xor_b32 v13, v131, v3
v_or_b32 v12, v12, v13
v_xor_b32 v13, v135, v3
v_or_b32 v12, v12, v13
v_xor_b32 v13, v139, v3
v_or_b32 v12, v12, v13
v_xor_b32 v13, v143, v3
v_or_b32 v12, v12, v13
v_cmp_ne_u32 vcc, 0, v12
s_cbranch_vccz L_px_ok
s_sub_u32 s62, s62, 1
s_cmp_lg_u32 s62, 0
s_cbranch_scc1 L_px
v_mov_b32 v12, 0
v_mov_b32 v13, 8
global_store_dword v12, v13, s[24:25]
L_px_ok:
s_cmp_eq_u64 s[96:97], 0
s_cbranch_scc1 L_nw0
s_mov_b64 exec, s[96:97]
ds_write_b64 v52, v[112:113] offset:0
ds_write_b32 v54, v114 offset:0
ds_write_b64 v52, v[116:117] offset:1536
ds_write_b32 v54, v118 offset:1536
ds_write_b64 v52, v[120:121] offset:3072
ds_write_b32 v54, v122 offset:3072
ds_write_b64 v52, v[124:125] offset:4608
ds_write_b32 v54, v126 offset:4608
s_mov_b64 exec, -1
s_waitcnt lgkmcnt(0)
L_nw0:
s_cmp_eq_u64 s[98:99], 0
s_cbranch_scc1 L_nw1
s_mov_b64 exec, s[98:99]
ds_write_b64 v52, v[128:129] offset:1024
ds_write_b32 v54, v130 offset:1024
ds_write_b64 v52, v[132:133] offset:2560
ds_write_b32 v54, v134 offset:2560
ds_write_b64 v52, v[136:137] offset:4096
ds_write_b32 v54, v138 offset:4096
ds_write_b64 v52, v[140:141] offset:5632
ds_write_b32 v54, v142 offset:5632
s_mov_b64 exec, -1
s_waitcnt lgkmcnt(0)
L_nw1:
v_mov_b32 v12, 1
ds_write_b32 v53, v12 offset:4
L_nox:
s_waitcnt vmcnt(0) lgkmcnt(0)
s_sub_u32 s65, s74, s38
v_cmp_eq_u32 vcc, v195, v3
v_subrev_u32 v192, s38, v192
v_mov_b32 v12, s65
v_cndmask_b32 v192, v12, v192, vcc
v_mov_b32 v12, 0x190
v_mov_b32 v13, -400
v_med3_i32 v192, v192, v12, v13
s_nop 1
v_add_u32_dpp v192, v192, v192 quad_perm:[1,0,3,2] row_mask:0xf bank_mask:0xf
s_nop 1
v_add_u32_dpp v192, v192, v192 quad_perm:[2,3,0,1] row_mask:0xf bank_mask:0xf
s_nop 1
v_add_u32_dpp v192, v192, v192 row_half_mirror row_mask:0xf bank_mask:0xf
s_nop 1
v_add_u32_dpp v192, v192, v192 row_mirror row_mask:0xf bank_mask:0xf
v_mov_b32 v12, v192
s_nop 1
v_permlane16_swap_b32 v192, v12
v_add_u32 v192, v192, v12
v_mov_b32 v12, v192
s_nop 1
v_permlane32_swap_b32 v192, v12
v_add_u32 v192, v192, v12
ds_read_b32 v14, v53
v_readfirstlane_b32 s65, v192
s_nop 0
s_ashr_i32 s65, s65, 6
s_abs_i32 s66, s65
s_sub_i32 s66, s66, 20
s_max_i32 s66, s66, 0
s_mul_i32 s66, s66, 15
s_lshr_b32 s66, s66, 8
s_min_u32 s66, s66, 10
s_waitcnt lgkmcnt(0)
v_readfirstlane_b32 s67, v14
s_nop 0
s_lshr_b32 s67, s67, 2
s_add_u32 s67, s67, s66
s_cmp_eq_u32 s66, 0
s_cselect_b32 s67, 0, s67
s_sub_i32 s66, 0, s67
s_cmp_lt_i32 s65, 0
s_cselect_b32 s67, s67, s66
v_mov_b32 v12, s67
ds_write_b32 v53, v12 offset:8
L_hb4:
v_mul_u32_u24 v6, 12, v1
v_add_u32 v6, 132608, v6
v_mov_b32 v10, 133376
s_lshl_b32 s66, s49, 3
s_add_u32 s66, s66, s50
s_lshl_b32 s66, s66, 11
s_add_u32 s66, s66, 1048576
v_mov_b32 v53, 137872
s_mov_b32 s62, 262144
L_hw2:
ds_read_b32 v12, v53
s_sub_u32 s62, s62, 1
s_cmp_eq_u32 s62, 0
s_cbranch_scc1 L_hw2_ok
s_waitcnt lgkmcnt(0)
v_readfirstlane_b32 s65, v12
s_nop 0
s_cmp_ge_u32 s65, 116
s_cbranch_scc1 L_hw2_ok

s_branch L_hw2
L_hw2_ok:
ds_read_b64 v[56:57], v10 offset:0
ds_read_b64 v[58:59], v10 offset:1024
ds_read_b64 v[60:61], v10 offset:2048
ds_read_b64 v[62:63], v10 offset:3072
s_waitcnt lgkmcnt(0)
v_max3_f32 v16, v56, v58, v60
v_max_f32 v16, v16, v62
v_sub_f32 v56, v56, v16
v_sub_f32 v58, v58, v16
v_sub_f32 v60, v60, v16
v_sub_f32 v62, v62, v16
v_exp_f32 v56, v56
v_exp_f32 v58, v58
v_exp_f32 v60, v60
v_exp_f32 v62, v62
v_mov_b32 v39, v3
v_mov_b32 v19, v3
v_mov_b32 v18, v3
v_mul_f32 v17, v56, v57
v_fmac_f32 v17, v58, v59
v_fmac_f32 v17, v60, v61
v_fmac_f32 v17, v62, v63
v_add_u32 v45, 1024, v6
v_add_u32 v46, 2048, v6
v_add_u32 v47, 3072, v6
s_mov_b32 s37, s66
s_mov_b32 s62, 262144
L_cp1:
ds_read_b32 v12, v53
s_sub_u32 s62, s62, 1
s_cmp_eq_u32 s62, 0
s_cbranch_scc1 L_cp1_ok
s_waitcnt lgkmcnt(0)
v_readfirstlane_b32 s65, v12
s_nop 0
s_cmp_ge_u32 s65, 136
s_cbranch_scc1 L_cp1_ok

s_branch L_cp1
L_cp1_ok:
s_memrealtime s[74:75]
s_lshl_b32 s66, s2, 4
s_add_u32 s66, s66, 4067328
v_mov_b32 v39, v3
s_waitcnt lgkmcnt(0)
s_add_u32 s38, s74, 0
v_mov_b32 v36, s38
s_mov_b64 exec, 1
buffer_store_dwordx4 v[36:39], v2, s[44:47], s66 offen sc1
s_mov_b64 exec, -1
s_mov_b32 s62, 262144
L_cg1:
ds_read_b32 v12, v53
s_sub_u32 s62, s62, 1
s_cmp_eq_u32 s62, 0
s_cbranch_scc1 L_cg1_ok
s_waitcnt lgkmcnt(0)
v_readfirstlane_b32 s65, v12
s_nop 0
s_cmp_ge_u32 s65, 148
s_cbranch_scc1 L_cg1_ok

s_branch L_cg1
L_cg1_ok:
v_lshlrev_b32 v14, 6, v1
v_bfe_u32 v15, v1, 1, 2
v_lshl_add_u32 v14, v15, 4, v14
s_mov_b32 s66, 4067328
buffer_load_dwordx4 v[192:195], v14, s[44:47], s66 offen sc1
s_memrealtime s[74:75]
s_waitcnt vmcnt(0) lgkmcnt(0)
s_sub_u32 s65, s74, s38
v_cmp_eq_u32 vcc, v195, v3
v_subrev_u32 v192, s38, v192
v_mov_b32 v12, s65
v_cndmask_b32 v192, v12, v192, vcc
v_mov_b32 v12, 0x190
v_mov_b32 v13, -400
v_med3_i32 v192, v192, v12, v13
s_nop 1
v_add_u32_dpp v192, v192, v192 quad_perm:[1,0,3,2] row_mask:0xf bank_mask:0xf
s_nop 1
v_add_u32_dpp v192, v192, v192 quad_perm:[2,3,0,1] row_mask:0xf bank_mask:0xf
s_nop 1
v_add_u32_dpp v192, v192, v192 row_half_mirror row_mask:0xf bank_mask:0xf
s_nop 1
v_add_u32_dpp v192, v192, v192 row_mirror row_mask:0xf bank_mask:0xf
v_mov_b32 v12, v192
s_nop 1
v_permlane16_swap_b32 v192, v12
v_add_u32 v192, v192, v12
v_mov_b32 v12, v192
s_nop 1
v_permlane32_swap_b32 v192, v12
v_add_u32 v192, v192, v12
ds_read_b32 v14, v53
v_readfirstlane_b32 s65, v192
s_nop 0
s_ashr_i32 s65, s65, 6
s_abs_i32 s66, s65
s_sub_i32 s66, s66, 20
s_max_i32 s66, s66, 0
s_mul_i32 s66, s66, 15
s_lshr_b32 s66, s66, 8
s_min_u32 s66, s66, 10
s_waitcnt lgkmcnt(0)
v_readfirstlane_b32 s67, v14
s_nop 0
s_lshr_b32 s67, s67, 2
s_add_u32 s67, s67, s66
s_cmp_eq_u32 s66, 0
s_cselect_b32 s67, 0, s67
s_sub_i32 s66, 0, s67
s_cmp_lt_i32 s65, 0
s_cselect_b32 s67, s67, s66
v_mov_b32 v12, s67
ds_write_b32 v53, v12 offset:8
s_mov_b32 s66, s37
v_mov_b32 v39, v3
s_barrier
ds_read2_b32 v[64:65], v6 offset0:0 offset1:1
ds_read_b32 v66, v6 offset:8
ds_read2_b32 v[68:69], v45 offset0:0 offset1:1
ds_read_b32 v70, v45 offset:8
ds_read2_b32 v[72:73], v46 offset0:0 offset1:1
ds_read_b32 v74, v46 offset:8
ds_read2_b32 v[76:77], v47 offset0:0 offset1:1
ds_read_b32 v78, v47 offset:8
s_waitcnt lgkmcnt(0)
v_mul_f32 v36, v56, v64
v_mul_f32 v37, v56, v65
v_mul_f32 v38, v56, v66
v_fmac_f32 v36, v58, v68
v_fmac_f32 v37, v58, v69
v_fmac_f32 v38, v58, v70
v_fmac_f32 v36, v60, v72
v_fmac_f32 v37, v60, v73
v_fmac_f32 v38, v60, v74
v_fmac_f32 v36, v62, v76
v_fmac_f32 v37, v62, v77
v_fmac_f32 v38, v62, v78
buffer_store_dwordx4 v[36:39], v2, s[44:47], s66 offen sc1
s_mov_b64 exec, 1
buffer_store_dwordx4 v[16:19], v2, s[44:47], s66 offen offset:1024 sc1
s_mov_b64 exec, -1
s_cmp_ge_u32 s50, 5
s_cbranch_scc1 L_hnb5
s_barrier
L_hnb5:
s_cmp_eq_u32 s55, 0
s_cbranch_scc1 L_hdone
buffer_store_dwordx4 v[176:179], v2, s[44:47], s39 offen sc1
s_add_u32 s39, s39, 16384
buffer_store_dwordx4 v[180:183], v2, s[44:47], s39 offen sc1
s_add_u32 s39, s39, 16384
buffer_store_dwordx4 v[184:187], v2, s[44:47], s39 offen sc1
s_add_u32 s39, s39, 16384
buffer_store_dwordx4 v[188:191], v2, s[44:47], s39 offen sc1
s_mov_b32 s62, 32768
L_pb:
buffer_load_dwordx4 v[64:67], v29, s[44:47], s40 offen sc1
buffer_load_dwordx4 v[68:71], v29, s[44:47], s41 offen sc1
buffer_load_dwordx4 v[72:75], v29, s[44:47], s42 offen sc1
buffer_load_dwordx4 v[76:79], v29, s[44:47], s43 offen sc1
s_waitcnt vmcnt(0)
v_xor_b32 v12, v67, v3
v_xor_b32 v13, v71, v3
v_or_b32 v12, v12, v13
v_xor_b32 v13, v75, v3
v_or_b32 v12, v12, v13
v_xor_b32 v13, v79, v3
v_or_b32 v12, v12, v13
v_cmp_ne_u32 vcc, 0, v12
s_cbranch_vccz L_pb_ok
s_sub_u32 s62, s62, 1
s_cmp_lg_u32 s62, 0
s_cbranch_scc1 L_pb
v_mov_b32 v12, 0
v_mov_b32 v13, 5
global_store_dword v12, v13, s[24:25]
L_pb_ok:
v_add_f32 v64, v64, v68
v_add_f32 v72, v72, v76
v_add_f32 v64, v64, v72
v_mov_b32 v12, v64
s_nop 1
v_permlane16_swap_b32 v64, v12
v_add_f32 v64, v64, v12
v_mov_b32 v12, v64
s_nop 1
v_permlane32_swap_b32 v64, v12
v_add_f32 v64, v64, v12
v_add_f32 v65, v65, v69
v_add_f32 v73, v73, v77
v_add_f32 v65, v65, v73
v_mov_b32 v12, v65
s_nop 1
v_permlane16_swap_b32 v65, v12
v_add_f32 v65, v65, v12
v_mov_b32 v12, v65
s_nop 1
v_permlane32_swap_b32 v65, v12
v_add_f32 v65, v65, v12
v_cvt_pk_bf16_f32 v12, v64, v65
v_lshlrev_b32 v64, 16, v12
v_and_b32 v65, 0xffff0000, v12
v_mul_f32 v12, s64, v64
v_max_f32 v12, 0xc2fc0000, v12
v_exp_f32 v12, -v12
s_nop 0
v_add_f32 v12, 1.0, v12
v_rcp_f32 v13, v12
s_nop 0
v_mul_f32 v30, v64, v13
v_fma_f32 v14, -v30, v12, v64
v_fma_f32 v30, v14, v13, v30
v_mul_f32 v12, s64, v65
v_max_f32 v12, 0xc2fc0000, v12
v_exp_f32 v12, -v12
s_nop 0
v_add_f32 v12, 1.0, v12
v_rcp_f32 v13, v12
s_nop 0
v_mul_f32 v31, v65, v13
v_fma_f32 v14, -v31, v12, v65
v_fma_f32 v31, v14, v13, v31
v_cvt_pk_bf16_f32 v12, v30, v31
v_lshlrev_b32 v30, 16, v12
v_and_b32 v31, 0xffff0000, v12
s_mov_b32 s62, 32768
L_py:
buffer_load_dwordx4 v[80:83], v29, s[44:47], s28 offen sc1
buffer_load_dwordx4 v[84:87], v29, s[44:47], s29 offen sc1
buffer_load_dwordx4 v[88:91], v29, s[44:47], s30 offen sc1
buffer_load_dwordx4 v[92:95], v29, s[44:47], s31 offen sc1
buffer_load_dwordx4 v[96:99], v29, s[44:47], s32 offen sc1
buffer_load_dwordx4 v[100:103], v29, s[44:47], s33 offen sc1
buffer_load_dwordx4 v[104:107], v29, s[44:47], s34 offen sc1
buffer_load_dwordx4 v[108:111], v29, s[44:47], s35 offen sc1
s_waitcnt vmcnt(0)
v_xor_b32 v12, v83, v3
v_xor_b32 v13, v87, v3
v_or_b32 v12, v12, v13
v_xor_b32 v13, v91, v3
v_or_b32 v12, v12, v13
v_xor_b32 v13, v95, v3
v_or_b32 v12, v12, v13
v_xor_b32 v13, v99, v3
v_or_b32 v12, v12, v13
v_xor_b32 v13, v103, v3
v_or_b32 v12, v12, v13
v_xor_b32 v13, v107, v3
v_or_b32 v12, v12, v13
v_xor_b32 v13, v111, v3
v_or_b32 v12, v12, v13
v_cmp_ne_u32 vcc, 0, v12
s_cbranch_vccz L_py_ok
s_sub_u32 s62, s62, 1
s_cmp_lg_u32 s62, 0
s_cbranch_scc1 L_py
v_mov_b32 v12, 0
v_mov_b32 v13, 6
global_store_dword v12, v13, s[24:25]
L_py_ok:
v_add_f32 v160, v80, v84
v_add_f32 v162, v88, v92
v_add_f32 v164, v96, v100
v_add_f32 v166, v104, v108
v_add_f32 v161, v81, v85
v_add_f32 v163, v89, v93
v_add_f32 v165, v97, v101
v_add_f32 v167, v105, v109
v_add_f32 v160, v160, v162
v_add_f32 v164, v164, v166
v_add_f32 v160, v160, v164
v_add_f32 v161, v161, v163
v_add_f32 v165, v165, v167
v_add_f32 v161, v161, v165
v_mov_b32 v12, v160
s_nop 1
v_permlane16_swap_b32 v160, v12
v_add_f32 v160, v160, v12
v_mov_b32 v12, v160
s_nop 1
v_permlane32_swap_b32 v160, v12
v_add_f32 v160, v160, v12
v_mov_b32 v13, v161
s_nop 1
v_permlane16_swap_b32 v161, v13
v_add_f32 v161, v161, v13
v_mov_b32 v13, v161
s_nop 1
v_permlane32_swap_b32 v161, v13
v_add_f32 v161, v161, v13
v_cvt_pk_bf16_f32 v12, v160, v161
v_lshlrev_b32 v160, 16, v12
v_and_b32 v161, 0xffff0000, v12
v_mul_f32 v160, v160, v30
v_mul_f32 v161, v161, v31
v_cvt_pk_bf16_f32 v12, v160, v161
v_lshlrev_b32 v160, 16, v12
v_and_b32 v161, 0xffff0000, v12
v_add_f32 v160, v160, v32
v_add_f32 v161, v161, v33
v_cvt_pk_bf16_f32 v160, v160, v161
s_mov_b64 exec, 0xffff
global_store_short v34, v160, s[22:23]
global_store_short_d16_hi v34, v160, s[22:23] offset:32
s_cmp_lg_u32 s69, 0
s_cbranch_scc1 L_hdone
s_mov_b64 exec, 1
v_mov_b32 v12, 0
global_store_dword v12, v3, s[26:27] sc1
L_hdone:
L_end:
s_endpgm
.section .rodata,"a"
.p2align 6
.amdhsa_kernel recurrent_scan__gqa_block_cached__glu_gated_reglu__decode_kernel
.amdhsa_next_free_vgpr 244
.amdhsa_next_free_sgpr 100
.amdhsa_accum_offset 244
.amdhsa_group_segment_fixed_size 0
.amdhsa_kernarg_size 96
.amdhsa_user_sgpr_count 2
.amdhsa_user_sgpr_kernarg_segment_ptr 1
.amdhsa_system_sgpr_workgroup_id_x 1
.amdhsa_float_denorm_mode_32 3
.end_amdhsa_kernel
```
